```python
import torch

def _softmax(x, axis=-1):
    return torch.softmax(x, dim=axis)
def _gelu(x):
    return torch.nn.functional.gelu(x, approximate="tanh")
def _silu(x):
    return torch.nn.functional.silu(x)
def _sigmoid(x):
    return torch.sigmoid(x)
def _layernorm(x, axis=-1, eps=1e-5):
    m = x.mean(dim=axis, keepdim=True)
    v = x.var(dim=axis, keepdim=True, unbiased=False)
    return (x - m) / torch.sqrt(v + eps)
def _scatter_add(tgt, idx, src, axis=0):
    return tgt.clone().index_add_(axis, idx, src)
def _segment_sum(src, seg, n):
    out = torch.zeros((n,) + src.shape[1:], dtype=src.dtype)
    return out.index_add_(0, seg, src)
def _pad(x, pw):
    flat = tuple(v for pair in reversed(pw) for v in pair)
    return torch.nn.functional.pad(x, flat)

kernel_name = 'recurrent_scan__mha_block_cached__glu_gated_swiglu__decode'

def setup_inputs():

    _w = (lambda a: (lambda t: t.to(torch.bfloat16) if t.is_floating_point() else t)(torch.as_tensor(a)))
    def _A_setup():
        B, Sq, D = 4, 1, 512
        H, Sk, Dh = 32, 8192, 128
        return {
            "x": _w((lambda *s: torch.randn(*s, dtype=torch.bfloat16) * 0.2)(B, Sq, D)),
            "k_cache": _w((lambda *s: torch.randn(*s, dtype=torch.bfloat16) * 1.6)(B, H, Sk, Dh)),
            "v_cache": _w((lambda *s: torch.randn(*s, dtype=torch.bfloat16) * 1.6)(B, H, Sk, Dh)),
            "wq": _w((lambda *s: torch.randn(*s, dtype=torch.bfloat16) * 1.6)(D, H * Dh) * (D ** -0.5)),
            "wo": _w((lambda *s: torch.randn(*s, dtype=torch.bfloat16) * 1.6)(H * Dh, D) * ((H * Dh) ** -0.5)),
        }
    _A_in = _A_setup()

    def _B_setup():
        B, S, D, F = 4, 1, 512, 1792
        return {
            "x": _w((lambda *s: torch.randn(*s, dtype=torch.bfloat16) * 0.2)(B, S, D)),
            "w1": _w((lambda *s: torch.randn(*s, dtype=torch.bfloat16) * 0.8)(D, F) * (2.0 / D) ** 0.5),
            "w3": _w((lambda *s: torch.randn(*s, dtype=torch.bfloat16) * 0.8)(D, F) * (2.0 / D) ** 0.5),
            "w2": _w((lambda *s: torch.randn(*s, dtype=torch.bfloat16) * 0.8)(F, D) * (2.0 / F) ** 0.5),
        }
    _B_in = _B_setup()

    return {
        "A_x": _A_in["x"],
        "A_k_cache": _A_in["k_cache"],
        "A_v_cache": _A_in["v_cache"],
        "A_wq": _A_in["wq"],
        "A_wo": _A_in["wo"],
        "B_x": _B_in["x"],
        "B_w1": _B_in["w1"],
        "B_w3": _B_in["w3"],
        "B_w2": _B_in["w2"],
    }

def reference(A_x, A_k_cache, A_v_cache, A_wq, A_wo, B_x, B_w1, B_w3, B_w2):
    def _A_ref(x, k_cache, v_cache, wq, wo):
        B, Sq, D = x.shape
        H, Dh = 32, 128
        q = (lambda x, *d: x.permute(*d))((x @ wq).reshape(B, Sq, H, Dh), 0, 2, 1, 3)
        scores = torch.einsum("bhqd,bhkd->bhqk", q, k_cache) * (Dh ** -0.5)
        p = _softmax(scores, axis=-1)
        o = torch.einsum("bhqk,bhkd->bhqd", p, v_cache)
        return (lambda x, *d: x.permute(*d))(o, 0, 2, 1, 3).reshape(B, Sq, H * Dh) @ wo

    def _B_ref(x, w1, w3, w2):
        gate = torch.einsum("bsd,df->bsf", x, w1)
        up = torch.einsum("bsd,df->bsf", x, w3)
        h = _silu(gate) * up
        out = torch.einsum("bsf,fd->bsd", h, w2)
        return out

    x = A_x
    xn = _layernorm(x, axis=-1)
    s = _A_ref(xn, A_k_cache, A_v_cache, A_wq, A_wo)
    g = _silu(_B_ref(xn, B_w1, B_w3, B_w2))
    return x + s * g
```

```asm
; @launch grid=(256,1,1) block=(512,1,1) lds=24832
.amdgcn_target "amdgcn-amd-amdhsa--gfx950"
.text
.globl recurrent_scan__mha_block_cached__glu_gated_swiglu__decode_kernel
.p2align 8
.type recurrent_scan__mha_block_cached__glu_gated_swiglu__decode_kernel,@function
recurrent_scan__mha_block_cached__glu_gated_swiglu__decode_kernel:
    s_cmp_ge_u32 s2, 256
    s_cbranch_scc1 L_end
    s_load_dwordx16 s[4:19], s[0:1], 0
    s_load_dwordx8 s[20:27], s[0:1], 64
    v_lshrrev_b32 v7, 6, v0
    v_and_b32 v1, 63, v0
    v_readfirstlane_b32 s28, v7
    v_lshrrev_b32 v5, 4, v1
    v_and_b32 v6, 15, v1
    v_lshlrev_b32 v4, 4, v1
    s_lshr_b32 s29, s2, 6
    s_and_b32 s32, s2, 63
    s_bfe_u32 s31, s2, 65539
    s_bfe_u32 s58, s2, 131076
    s_lshl_b32 s58, s58, 3
    s_and_b32 s30, s2, 7
    s_or_b32 s30, s30, s58
    s_lshl_b32 s34, s29, 1
    s_or_b32 s34, s34, s31
    s_cmp_ge_u32 s28, 4
    s_cbranch_scc1 L_aux
    s_lshl_b32 s61, s30, 16
    s_lshl_b32 s58, s34, 13
    s_add_u32 s61, s61, s58
    s_lshl_b32 s58, s28, 11
    s_add_u32 s61, s61, s58
    s_lshl_b32 s60, s61, 1
    v_lshrrev_b32 v38, 2, v6
    v_lshlrev_b32 v38, 8, v38
    v_and_b32 v39, 3, v6
    v_lshlrev_b32 v39, 4, v39
    v_lshlrev_b32 v40, 6, v5
    v_add3_u32 v2, v38, v39, v40
    v_mov_b32 v3, v2
    s_lshl_b32 s66, s29, 26
    s_lshl_b32 s58, s30, 21
    s_or_b32 s66, s66, s58
    s_lshl_b32 s58, s31, 15
    s_or_b32 s66, s66, s58
    s_lshl_b32 s58, s28, 10
    s_or_b32 s66, s66, s58
    s_waitcnt lgkmcnt(0)
    s_mov_b32 s36, s6
    s_mov_b32 s37, s7
    s_mov_b32 s38, 0x10000000
    s_mov_b32 s39, 0x00020000
    s_add_u32 s58, s66, 0x0
    buffer_load_dwordx4 v[64:67], v2, s[36:39], s58 offen nt
    s_mov_b32 s44, s12
    s_mov_b32 s45, s13
    s_mov_b32 s46, 0x400000
    s_mov_b32 s47, 0x00020000
    buffer_load_dwordx4 v[48:51], v4, s[44:47], s60 offen offset:0
    s_mov_b32 s48, s20
    s_mov_b32 s49, s21
    s_mov_b32 s50, 0x1c0000
    s_mov_b32 s51, 0x00020000
    buffer_load_dwordx4 v[48:51], v4, s[48:51], s61 offen offset:0
    s_waitcnt vmcnt(2)
    buffer_load_dwordx4 v[48:51], v4, s[44:47], s60 offen offset:1024
    buffer_load_dwordx4 v[48:51], v4, s[44:47], s60 offen offset:2048
    buffer_load_dwordx4 v[48:51], v4, s[44:47], s60 offen offset:3072
    s_waitcnt vmcnt(5)
    buffer_load_dwordx4 v[48:51], v4, s[48:51], s61 offen offset:1024
    s_mov_b32 s40, s6
    s_mov_b32 s41, s7
    s_mov_b32 s42, 0x10000000
    s_mov_b32 s43, 0x00020000
    v_and_b32 v38, 1, v6
    v_lshlrev_b32 v38, 4, v38
    v_mov_b32 v39, 0xffff
    v_lshlrev_b32 v38, v38, v39
    v_bfe_u32 v39, v6, 1, 2
    v_cmp_eq_u32 vcc, 0, v39
    s_nop 1
    v_cndmask_b32 v8, 0, v38, vcc
    v_cmp_eq_u32 vcc, 1, v39
    s_nop 1
    v_cndmask_b32 v9, 0, v38, vcc
    v_cmp_eq_u32 vcc, 2, v39
    s_nop 1
    v_cndmask_b32 v10, 0, v38, vcc
    v_cmp_eq_u32 vcc, 3, v39
    s_nop 1
    v_cndmask_b32 v11, 0, v38, vcc
    v_lshlrev_b32 v58, 2, v1
    s_lshl_b32 s60, s28, 12
    s_add_u32 s60, s60, 8192
    v_add_u32 v58, s60, v58
    v_mov_b32 v59, v58
    v_lshrrev_b32 v38, 2, v6
    v_lshlrev_b32 v38, 4, v38
    v_lshlrev_b32 v60, 6, v5
    v_add_u32 v60, v60, v38
    v_mov_b32 v37, 0xff800000
    s_waitcnt vmcnt(5)
    s_add_u32 s58, s66, 0x1000
    buffer_load_dwordx4 v[68:71], v2, s[36:39], s58 offen nt
    s_waitcnt vmcnt(5)
    s_add_u32 s58, s66, 0x2000
    buffer_load_dwordx4 v[72:75], v2, s[36:39], s58 offen nt
    s_waitcnt vmcnt(5)
    s_add_u32 s58, s66, 0x3000
    buffer_load_dwordx4 v[76:79], v2, s[36:39], s58 offen nt
    s_waitcnt vmcnt(5)
    s_add_u32 s58, s66, 0x4000
    buffer_load_dwordx4 v[80:83], v2, s[36:39], s58 offen nt
    s_waitcnt vmcnt(5)
    s_add_u32 s58, s66, 0x5000
    buffer_load_dwordx4 v[84:87], v2, s[36:39], s58 offen nt
    s_waitcnt vmcnt(5)
    s_add_u32 s58, s66, 0x6000
    buffer_load_dwordx4 v[88:91], v2, s[36:39], s58 offen nt
    s_waitcnt vmcnt(5)
    s_add_u32 s58, s66, 0x7000
    buffer_load_dwordx4 v[92:95], v2, s[36:39], s58 offen nt
    s_waitcnt vmcnt(5)
    s_add_u32 s58, s66, 0x10000
    buffer_load_dwordx4 v[96:99], v2, s[36:39], s58 offen nt
    s_waitcnt vmcnt(5)
    s_add_u32 s58, s66, 0x11000
    buffer_load_dwordx4 v[100:103], v2, s[36:39], s58 offen nt
    s_waitcnt vmcnt(5)
    s_add_u32 s58, s66, 0x12000
    buffer_load_dwordx4 v[104:107], v2, s[36:39], s58 offen nt
    s_waitcnt vmcnt(5)
    s_add_u32 s58, s66, 0x13000
    buffer_load_dwordx4 v[108:111], v2, s[36:39], s58 offen nt
    s_waitcnt vmcnt(5)
    s_add_u32 s58, s66, 0x14000
    buffer_load_dwordx4 v[112:115], v2, s[36:39], s58 offen nt
    s_waitcnt vmcnt(5)
    s_add_u32 s58, s66, 0x15000
    buffer_load_dwordx4 v[116:119], v2, s[36:39], s58 offen nt
    s_waitcnt vmcnt(5)
    s_add_u32 s58, s66, 0x16000
    buffer_load_dwordx4 v[120:123], v2, s[36:39], s58 offen nt
    s_waitcnt vmcnt(5)
    s_add_u32 s58, s66, 0x17000
    buffer_load_dwordx4 v[124:127], v2, s[36:39], s58 offen nt
    s_waitcnt vmcnt(5)
    s_add_u32 s58, s66, 0x20000
    buffer_load_dwordx4 v[128:131], v2, s[36:39], s58 offen nt
    s_waitcnt vmcnt(5)
    s_add_u32 s58, s66, 0x21000
    buffer_load_dwordx4 v[132:135], v2, s[36:39], s58 offen nt
    s_waitcnt vmcnt(5)
    s_add_u32 s58, s66, 0x22000
    buffer_load_dwordx4 v[136:139], v2, s[36:39], s58 offen nt
    s_waitcnt vmcnt(5)
    s_add_u32 s58, s66, 0x23000
    buffer_load_dwordx4 v[140:143], v2, s[36:39], s58 offen nt
    s_waitcnt vmcnt(5)
    s_add_u32 s58, s66, 0x24000
    buffer_load_dwordx4 v[144:147], v2, s[36:39], s58 offen nt
    s_waitcnt vmcnt(5)
    s_add_u32 s58, s66, 0x25000
    buffer_load_dwordx4 v[148:151], v2, s[36:39], s58 offen nt
    s_waitcnt vmcnt(5)
    s_add_u32 s58, s66, 0x26000
    buffer_load_dwordx4 v[152:155], v2, s[36:39], s58 offen nt
    s_waitcnt vmcnt(5)
    s_add_u32 s58, s66, 0x27000
    buffer_load_dwordx4 v[156:159], v2, s[36:39], s58 offen nt
    s_waitcnt vmcnt(5)
    s_add_u32 s58, s66, 0x30000
    buffer_load_dwordx4 v[160:163], v2, s[36:39], s58 offen nt
    s_waitcnt vmcnt(5)
    s_add_u32 s58, s66, 0x31000
    buffer_load_dwordx4 v[164:167], v2, s[36:39], s58 offen nt
    s_waitcnt vmcnt(5)
    s_add_u32 s58, s66, 0x32000
    buffer_load_dwordx4 v[168:171], v2, s[36:39], s58 offen nt
    s_waitcnt vmcnt(5)
    s_add_u32 s58, s66, 0x33000
    buffer_load_dwordx4 v[172:175], v2, s[36:39], s58 offen nt
    s_waitcnt vmcnt(5)
    s_add_u32 s58, s66, 0x34000
    buffer_load_dwordx4 v[176:179], v2, s[36:39], s58 offen nt
    s_waitcnt vmcnt(5)
    s_add_u32 s58, s66, 0x35000
    buffer_load_dwordx4 v[180:183], v2, s[36:39], s58 offen nt
    s_waitcnt vmcnt(5)
    s_add_u32 s58, s66, 0x36000
    buffer_load_dwordx4 v[184:187], v2, s[36:39], s58 offen nt
    s_waitcnt vmcnt(5)
    s_add_u32 s58, s66, 0x37000
    buffer_load_dwordx4 v[188:191], v2, s[36:39], s58 offen nt
    s_waitcnt vmcnt(5)
    s_add_u32 s58, s66, 0x40000
    buffer_load_dwordx4 v[192:195], v2, s[36:39], s58 offen nt
    s_waitcnt vmcnt(5)
    s_add_u32 s58, s66, 0x41000
    buffer_load_dwordx4 v[196:199], v2, s[36:39], s58 offen nt
    s_waitcnt vmcnt(5)
    s_add_u32 s58, s66, 0x42000
    buffer_load_dwordx4 v[200:203], v2, s[36:39], s58 offen nt
    s_waitcnt vmcnt(5)
    s_add_u32 s58, s66, 0x43000
    buffer_load_dwordx4 v[204:207], v2, s[36:39], s58 offen nt
    s_waitcnt vmcnt(5)
    s_add_u32 s58, s66, 0x44000
    buffer_load_dwordx4 v[208:211], v2, s[36:39], s58 offen nt
    s_waitcnt vmcnt(5)
    s_add_u32 s58, s66, 0x45000
    buffer_load_dwordx4 v[212:215], v2, s[36:39], s58 offen nt
    s_waitcnt vmcnt(5)
    s_add_u32 s58, s66, 0x46000
    buffer_load_dwordx4 v[216:219], v2, s[36:39], s58 offen nt
    s_waitcnt vmcnt(5)
    s_add_u32 s58, s66, 0x47000
    buffer_load_dwordx4 v[220:223], v2, s[36:39], s58 offen nt
    s_waitcnt vmcnt(5)
    s_add_u32 s58, s66, 0x50000
    buffer_load_dwordx4 v[224:227], v2, s[36:39], s58 offen nt
    s_waitcnt vmcnt(5)
    s_add_u32 s58, s66, 0x51000
    buffer_load_dwordx4 v[228:231], v2, s[36:39], s58 offen nt
    s_waitcnt vmcnt(5)
    s_add_u32 s58, s66, 0x52000
    buffer_load_dwordx4 v[232:235], v2, s[36:39], s58 offen nt
    s_waitcnt vmcnt(5)
    s_add_u32 s58, s66, 0x53000
    buffer_load_dwordx4 v[236:239], v2, s[36:39], s58 offen nt
    s_waitcnt vmcnt(5)
    s_add_u32 s58, s66, 0x54000
    buffer_load_dwordx4 v[240:243], v2, s[36:39], s58 offen nt
    s_waitcnt vmcnt(5)
    s_add_u32 s58, s66, 0x55000
    buffer_load_dwordx4 v[244:247], v2, s[36:39], s58 offen nt
    s_waitcnt vmcnt(5)
    s_add_u32 s58, s66, 0x56000
    buffer_load_dwordx4 v[248:251], v2, s[36:39], s58 offen nt
    s_waitcnt vmcnt(5)
    s_add_u32 s58, s66, 0x57000
    buffer_load_dwordx4 v[252:255], v2, s[36:39], s58 offen nt
    s_barrier
    ds_read_b128 v[40:43], v60 offset:0
    v_and_b32 v38, 3, v6
    s_waitcnt lgkmcnt(0)
    v_cmp_eq_u32 vcc, 0, v38
    s_nop 1
    v_cndmask_b32 v12, 0, v40, vcc
    v_cndmask_b32 v13, 0, v41, vcc
    v_cndmask_b32 v14, 0, v42, vcc
    v_cndmask_b32 v15, 0, v43, vcc
    v_cmp_eq_u32 vcc, 1, v38
    s_nop 1
    v_cndmask_b32 v16, 0, v40, vcc
    v_cndmask_b32 v17, 0, v41, vcc
    v_cndmask_b32 v18, 0, v42, vcc
    v_cndmask_b32 v19, 0, v43, vcc
    v_cmp_eq_u32 vcc, 2, v38
    s_nop 1
    v_cndmask_b32 v20, 0, v40, vcc
    v_cndmask_b32 v21, 0, v41, vcc
    v_cndmask_b32 v22, 0, v42, vcc
    v_cndmask_b32 v23, 0, v43, vcc
    v_cmp_eq_u32 vcc, 3, v38
    s_nop 1
    v_cndmask_b32 v24, 0, v40, vcc
    v_cndmask_b32 v25, 0, v41, vcc
    v_cndmask_b32 v26, 0, v42, vcc
    v_cndmask_b32 v27, 0, v43, vcc
    s_nop 1
    s_waitcnt vmcnt(47)
    v_mfma_f32_16x16x32_bf16 v[28:31], v[64:67], v[12:15], 0
    s_add_u32 s58, s66, 0x60000
    buffer_load_dwordx4 v[64:67], v2, s[36:39], s58 offen nt
    s_waitcnt vmcnt(47)
    v_mfma_f32_16x16x32_bf16 v[28:31], v[68:71], v[16:19], v[28:31]
    s_add_u32 s58, s66, 0x61000
    buffer_load_dwordx4 v[68:71], v2, s[36:39], s58 offen nt
    s_waitcnt vmcnt(47)
    v_mfma_f32_16x16x32_bf16 v[28:31], v[72:75], v[20:23], v[28:31]
    s_add_u32 s58, s66, 0x62000
    buffer_load_dwordx4 v[72:75], v2, s[36:39], s58 offen nt
    s_waitcnt vmcnt(47)
    v_mfma_f32_16x16x32_bf16 v[28:31], v[76:79], v[24:27], v[28:31]
    s_add_u32 s58, s66, 0x63000
    buffer_load_dwordx4 v[76:79], v2, s[36:39], s58 offen nt
    s_waitcnt vmcnt(47)
    v_mfma_f32_16x16x32_bf16 v[32:35], v[80:83], v[12:15], 0
    s_add_u32 s58, s66, 0x64000
    buffer_load_dwordx4 v[80:83], v2, s[36:39], s58 offen nt
    s_nop 6
    v_mov_b32_dpp v36, v28 quad_perm:[0,1,2,3] row_mask:0xf bank_mask:0x1
    s_waitcnt vmcnt(47)
    v_mfma_f32_16x16x32_bf16 v[32:35], v[84:87], v[16:19], v[32:35]
    s_nop 0
    v_add_f32_dpp v36, v29, v36 row_ror:12 row_mask:0xf bank_mask:0x1
    s_waitcnt vmcnt(46)
    v_mfma_f32_16x16x32_bf16 v[32:35], v[88:91], v[20:23], v[32:35]
    s_nop 0
    v_add_f32_dpp v36, v30, v36 row_ror:8 row_mask:0xf bank_mask:0x1
    s_waitcnt vmcnt(45)
    v_mfma_f32_16x16x32_bf16 v[32:35], v[92:95], v[24:27], v[32:35]
    s_nop 0
    v_add_f32_dpp v36, v31, v36 row_ror:4 row_mask:0xf bank_mask:0x1
    s_waitcnt vmcnt(44)
    v_mfma_f32_16x16x32_bf16 v[28:31], v[96:99], v[12:15], 0
    s_nop 6
    v_mov_b32_dpp v36, v32 row_ror:4 row_mask:0xf bank_mask:0x2
    s_waitcnt vmcnt(43)
    v_mfma_f32_16x16x32_bf16 v[28:31], v[100:103], v[16:19], v[28:31]
    s_nop 0
    v_add_f32_dpp v36, v33, v36 quad_perm:[0,1,2,3] row_mask:0xf bank_mask:0x2
    s_waitcnt vmcnt(42)
    v_mfma_f32_16x16x32_bf16 v[28:31], v[104:107], v[20:23], v[28:31]
    s_nop 0
    v_add_f32_dpp v36, v34, v36 row_ror:12 row_mask:0xf bank_mask:0x2
    s_waitcnt vmcnt(41)
    v_mfma_f32_16x16x32_bf16 v[28:31], v[108:111], v[24:27], v[28:31]
    s_nop 0
    v_add_f32_dpp v36, v35, v36 row_ror:8 row_mask:0xf bank_mask:0x2
    s_waitcnt vmcnt(40)
    v_mfma_f32_16x16x32_bf16 v[32:35], v[112:115], v[12:15], 0
    s_nop 6
    v_mov_b32_dpp v36, v28 row_ror:8 row_mask:0xf bank_mask:0x4
    s_waitcnt vmcnt(39)
    v_mfma_f32_16x16x32_bf16 v[32:35], v[116:119], v[16:19], v[32:35]
    s_nop 0
    v_add_f32_dpp v36, v29, v36 row_ror:4 row_mask:0xf bank_mask:0x4
    s_waitcnt vmcnt(38)
    v_mfma_f32_16x16x32_bf16 v[32:35], v[120:123], v[20:23], v[32:35]
    s_nop 0
    v_add_f32_dpp v36, v30, v36 quad_perm:[0,1,2,3] row_mask:0xf bank_mask:0x4
    s_waitcnt vmcnt(37)
    v_mfma_f32_16x16x32_bf16 v[32:35], v[124:127], v[24:27], v[32:35]
    s_nop 0
    v_add_f32_dpp v36, v31, v36 row_ror:12 row_mask:0xf bank_mask:0x4
    s_nop 7
    v_mov_b32_dpp v36, v32 row_ror:12 row_mask:0xf bank_mask:0x8
    s_nop 1
    v_add_f32_dpp v36, v33, v36 row_ror:8 row_mask:0xf bank_mask:0x8
    s_nop 1
    v_add_f32_dpp v36, v34, v36 row_ror:4 row_mask:0xf bank_mask:0x8
    s_nop 1
    v_add_f32_dpp v36, v35, v36 quad_perm:[0,1,2,3] row_mask:0xf bank_mask:0x8
    s_nop 1
    v_cvt_pk_bf16_f32 v38, v36, v36
    v_and_b32 v36, 0xffff0000, v38
    v_mul_f32 v39, 0x3db504f3, v36
    v_cvt_pk_bf16_f32 v38, v39, v39
    v_and_b32 v39, 0xffff0000, v38
    v_max_f32 v37, v37, v39
    ds_write_b32 v59, v39
    v_add_u32 v59, 256, v59
    s_waitcnt vmcnt(36)
    v_mfma_f32_16x16x32_bf16 v[28:31], v[128:131], v[12:15], 0
    s_waitcnt vmcnt(35)
    v_mfma_f32_16x16x32_bf16 v[28:31], v[132:135], v[16:19], v[28:31]
    s_waitcnt vmcnt(34)
    v_mfma_f32_16x16x32_bf16 v[28:31], v[136:139], v[20:23], v[28:31]
    s_waitcnt vmcnt(33)
    v_mfma_f32_16x16x32_bf16 v[28:31], v[140:143], v[24:27], v[28:31]
    s_waitcnt vmcnt(32)
    v_mfma_f32_16x16x32_bf16 v[32:35], v[144:147], v[12:15], 0
    s_nop 6
    v_mov_b32_dpp v36, v28 quad_perm:[0,1,2,3] row_mask:0xf bank_mask:0x1
    s_waitcnt vmcnt(31)
    v_mfma_f32_16x16x32_bf16 v[32:35], v[148:151], v[16:19], v[32:35]
    s_nop 0
    v_add_f32_dpp v36, v29, v36 row_ror:12 row_mask:0xf bank_mask:0x1
    s_waitcnt vmcnt(30)
    v_mfma_f32_16x16x32_bf16 v[32:35], v[152:155], v[20:23], v[32:35]
    s_nop 0
    v_add_f32_dpp v36, v30, v36 row_ror:8 row_mask:0xf bank_mask:0x1
    s_waitcnt vmcnt(29)
    v_mfma_f32_16x16x32_bf16 v[32:35], v[156:159], v[24:27], v[32:35]
    s_nop 0
    v_add_f32_dpp v36, v31, v36 row_ror:4 row_mask:0xf bank_mask:0x1
    s_waitcnt vmcnt(28)
    v_mfma_f32_16x16x32_bf16 v[28:31], v[160:163], v[12:15], 0
    s_nop 6
    v_mov_b32_dpp v36, v32 row_ror:4 row_mask:0xf bank_mask:0x2
    s_waitcnt vmcnt(27)
    v_mfma_f32_16x16x32_bf16 v[28:31], v[164:167], v[16:19], v[28:31]
    s_nop 0
    v_add_f32_dpp v36, v33, v36 quad_perm:[0,1,2,3] row_mask:0xf bank_mask:0x2
    s_waitcnt vmcnt(26)
    v_mfma_f32_16x16x32_bf16 v[28:31], v[168:171], v[20:23], v[28:31]
    s_nop 0
    v_add_f32_dpp v36, v34, v36 row_ror:12 row_mask:0xf bank_mask:0x2
    s_waitcnt vmcnt(25)
    v_mfma_f32_16x16x32_bf16 v[28:31], v[172:175], v[24:27], v[28:31]
    s_nop 0
    v_add_f32_dpp v36, v35, v36 row_ror:8 row_mask:0xf bank_mask:0x2
    s_waitcnt vmcnt(24)
    v_mfma_f32_16x16x32_bf16 v[32:35], v[176:179], v[12:15], 0
    s_nop 6
    v_mov_b32_dpp v36, v28 row_ror:8 row_mask:0xf bank_mask:0x4
    s_waitcnt vmcnt(23)
    v_mfma_f32_16x16x32_bf16 v[32:35], v[180:183], v[16:19], v[32:35]
    s_nop 0
    v_add_f32_dpp v36, v29, v36 row_ror:4 row_mask:0xf bank_mask:0x4
    s_waitcnt vmcnt(22)
    v_mfma_f32_16x16x32_bf16 v[32:35], v[184:187], v[20:23], v[32:35]
    s_nop 0
    v_add_f32_dpp v36, v30, v36 quad_perm:[0,1,2,3] row_mask:0xf bank_mask:0x4
    s_waitcnt vmcnt(21)
    v_mfma_f32_16x16x32_bf16 v[32:35], v[188:191], v[24:27], v[32:35]
    s_nop 0
    v_add_f32_dpp v36, v31, v36 row_ror:12 row_mask:0xf bank_mask:0x4
    s_nop 7
    v_mov_b32_dpp v36, v32 row_ror:12 row_mask:0xf bank_mask:0x8
    s_nop 1
    v_add_f32_dpp v36, v33, v36 row_ror:8 row_mask:0xf bank_mask:0x8
    s_nop 1
    v_add_f32_dpp v36, v34, v36 row_ror:4 row_mask:0xf bank_mask:0x8
    s_nop 1
    v_add_f32_dpp v36, v35, v36 quad_perm:[0,1,2,3] row_mask:0xf bank_mask:0x8
    s_nop 1
    v_cvt_pk_bf16_f32 v38, v36, v36
    v_and_b32 v36, 0xffff0000, v38
    v_mul_f32 v39, 0x3db504f3, v36
    v_cvt_pk_bf16_f32 v38, v39, v39
    v_and_b32 v39, 0xffff0000, v38
    v_max_f32 v37, v37, v39
    ds_write_b32 v59, v39
    v_add_u32 v59, 256, v59
    s_waitcnt vmcnt(20)
    v_mfma_f32_16x16x32_bf16 v[28:31], v[192:195], v[12:15], 0
    s_waitcnt vmcnt(19)
    v_mfma_f32_16x16x32_bf16 v[28:31], v[196:199], v[16:19], v[28:31]
    s_waitcnt vmcnt(18)
    v_mfma_f32_16x16x32_bf16 v[28:31], v[200:203], v[20:23], v[28:31]
    s_waitcnt vmcnt(17)
    v_mfma_f32_16x16x32_bf16 v[28:31], v[204:207], v[24:27], v[28:31]
    s_waitcnt vmcnt(16)
    v_mfma_f32_16x16x32_bf16 v[32:35], v[208:211], v[12:15], 0
    s_nop 6
    v_mov_b32_dpp v36, v28 quad_perm:[0,1,2,3] row_mask:0xf bank_mask:0x1
    s_waitcnt vmcnt(15)
    v_mfma_f32_16x16x32_bf16 v[32:35], v[212:215], v[16:19], v[32:35]
    s_nop 0
    v_add_f32_dpp v36, v29, v36 row_ror:12 row_mask:0xf bank_mask:0x1
    s_waitcnt vmcnt(14)
    v_mfma_f32_16x16x32_bf16 v[32:35], v[216:219], v[20:23], v[32:35]
    s_nop 0
    v_add_f32_dpp v36, v30, v36 row_ror:8 row_mask:0xf bank_mask:0x1
    s_waitcnt vmcnt(13)
    v_mfma_f32_16x16x32_bf16 v[32:35], v[220:223], v[24:27], v[32:35]
    s_nop 0
    v_add_f32_dpp v36, v31, v36 row_ror:4 row_mask:0xf bank_mask:0x1
    s_waitcnt vmcnt(12)
    v_mfma_f32_16x16x32_bf16 v[28:31], v[224:227], v[12:15], 0
    s_nop 6
    v_mov_b32_dpp v36, v32 row_ror:4 row_mask:0xf bank_mask:0x2
    s_waitcnt vmcnt(11)
    v_mfma_f32_16x16x32_bf16 v[28:31], v[228:231], v[16:19], v[28:31]
    s_nop 0
    v_add_f32_dpp v36, v33, v36 quad_perm:[0,1,2,3] row_mask:0xf bank_mask:0x2
    s_waitcnt vmcnt(10)
    v_mfma_f32_16x16x32_bf16 v[28:31], v[232:235], v[20:23], v[28:31]
    s_nop 0
    v_add_f32_dpp v36, v34, v36 row_ror:12 row_mask:0xf bank_mask:0x2
    s_waitcnt vmcnt(9)
    v_mfma_f32_16x16x32_bf16 v[28:31], v[236:239], v[24:27], v[28:31]
    s_nop 0
    v_add_f32_dpp v36, v35, v36 row_ror:8 row_mask:0xf bank_mask:0x2
    s_waitcnt vmcnt(8)
    v_mfma_f32_16x16x32_bf16 v[32:35], v[240:243], v[12:15], 0
    s_nop 6
    v_mov_b32_dpp v36, v28 row_ror:8 row_mask:0xf bank_mask:0x4
    s_waitcnt vmcnt(7)
    v_mfma_f32_16x16x32_bf16 v[32:35], v[244:247], v[16:19], v[32:35]
    s_nop 0
    v_add_f32_dpp v36, v29, v36 row_ror:4 row_mask:0xf bank_mask:0x4
    s_waitcnt vmcnt(6)
    v_mfma_f32_16x16x32_bf16 v[32:35], v[248:251], v[20:23], v[32:35]
    s_nop 0
    v_add_f32_dpp v36, v30, v36 quad_perm:[0,1,2,3] row_mask:0xf bank_mask:0x4
    s_waitcnt vmcnt(5)
    v_mfma_f32_16x16x32_bf16 v[32:35], v[252:255], v[24:27], v[32:35]
    s_nop 0
    v_add_f32_dpp v36, v31, v36 row_ror:12 row_mask:0xf bank_mask:0x4
    s_nop 7
    v_mov_b32_dpp v36, v32 row_ror:12 row_mask:0xf bank_mask:0x8
    s_nop 1
    v_add_f32_dpp v36, v33, v36 row_ror:8 row_mask:0xf bank_mask:0x8
    s_nop 1
    v_add_f32_dpp v36, v34, v36 row_ror:4 row_mask:0xf bank_mask:0x8
    s_nop 1
    v_add_f32_dpp v36, v35, v36 quad_perm:[0,1,2,3] row_mask:0xf bank_mask:0x8
    s_nop 1
    v_cvt_pk_bf16_f32 v38, v36, v36
    v_and_b32 v36, 0xffff0000, v38
    v_mul_f32 v39, 0x3db504f3, v36
    v_cvt_pk_bf16_f32 v38, v39, v39
    v_and_b32 v39, 0xffff0000, v38
    v_max_f32 v37, v37, v39
    ds_write_b32 v59, v39
    v_add_u32 v59, 256, v59
    s_waitcnt vmcnt(4)
    s_add_u32 s58, s66, 0x65000
    buffer_load_dwordx4 v[84:87], v2, s[36:39], s58 offen nt
    s_waitcnt vmcnt(4)
    s_add_u32 s58, s66, 0x66000
    buffer_load_dwordx4 v[88:91], v2, s[36:39], s58 offen nt
    s_waitcnt vmcnt(4)
    s_add_u32 s58, s66, 0x67000
    buffer_load_dwordx4 v[92:95], v2, s[36:39], s58 offen nt
    s_add_u32 s56, s66, 0x60000
    s_mov_b32 s59, 3
    s_lshl_b32 s58, s28, 2
    s_add_u32 s58, s58, 336
    v_mov_b32 v63, s58
    v_mov_b32 v61, 0
    v_mov_b32 v46, 1
L_kloop:
    s_add_u32 s57, s56, 0x20000
    s_cmp_eq_u32 s59, 15
    s_cbranch_scc0 L_knl
    s_mov_b32 s57, s66
    s_mov_b32 s40, s8
    s_mov_b32 s41, s9
    v_mov_b32 v3, v4
L_knl:
    s_waitcnt lgkmcnt(0)
    v_readfirstlane_b32 s68, v46
    s_cmp_eq_u32 s68, 1
    s_cbranch_scc1 L_k_b1
    s_cmp_eq_u32 s68, 2
    s_cbranch_scc1 L_k_b2
    s_cmp_eq_u32 s68, 3
    s_cbranch_scc1 L_k_b3
L_k_b0:
    s_waitcnt vmcnt(3)
    s_add_u32 s58, s56, 0x10000
    buffer_load_dwordx4 v[96:99], v2, s[36:39], s58 offen nt
    v_add_u32 v61, 1, v61
    ds_write_b32 v63, v61
    v_mfma_f32_16x16x32_bf16 v[28:31], v[64:67], v[12:15], 0
    s_waitcnt vmcnt(3)
    s_add_u32 s58, s56, 0x11000
    buffer_load_dwordx4 v[100:103], v2, s[36:39], s58 offen nt
    v_mfma_f32_16x16x32_bf16 v[28:31], v[68:71], v[16:19], v[28:31]
    s_waitcnt vmcnt(3)
    s_add_u32 s58, s56, 0x12000
    buffer_load_dwordx4 v[104:107], v2, s[36:39], s58 offen nt
    v_add_u32 v61, 1, v61
    ds_write_b32 v63, v61
    v_mfma_f32_16x16x32_bf16 v[28:31], v[72:75], v[20:23], v[28:31]
    s_waitcnt vmcnt(3)
    s_add_u32 s58, s56, 0x13000
    buffer_load_dwordx4 v[108:111], v2, s[36:39], s58 offen nt
    v_mfma_f32_16x16x32_bf16 v[28:31], v[76:79], v[24:27], v[28:31]
    s_waitcnt vmcnt(3)
    s_add_u32 s58, s56, 0x14000
    buffer_load_dwordx4 v[112:115], v2, s[36:39], s58 offen nt
    v_add_u32 v61, 1, v61
    ds_write_b32 v63, v61
    v_mfma_f32_16x16x32_bf16 v[32:35], v[80:83], v[12:15], 0
    s_nop 6
    v_mov_b32_dpp v36, v28 quad_perm:[0,1,2,3] row_mask:0xf bank_mask:0x1
    s_waitcnt vmcnt(3)
    s_add_u32 s58, s56, 0x15000
    buffer_load_dwordx4 v[116:119], v2, s[36:39], s58 offen nt
    v_mfma_f32_16x16x32_bf16 v[32:35], v[84:87], v[16:19], v[32:35]
    s_nop 0
    v_add_f32_dpp v36, v29, v36 row_ror:12 row_mask:0xf bank_mask:0x1
    s_waitcnt vmcnt(3)
    s_add_u32 s58, s56, 0x16000
    buffer_load_dwordx4 v[120:123], v2, s[36:39], s58 offen nt
    v_add_u32 v61, 1, v61
    ds_write_b32 v63, v61
    ds_read_b32 v46, v63 offset:16
    v_mfma_f32_16x16x32_bf16 v[32:35], v[88:91], v[20:23], v[32:35]
    s_nop 0
    v_add_f32_dpp v36, v30, v36 row_ror:8 row_mask:0xf bank_mask:0x1
    s_waitcnt vmcnt(3)
    s_add_u32 s58, s56, 0x17000
    buffer_load_dwordx4 v[124:127], v2, s[36:39], s58 offen nt
    v_mfma_f32_16x16x32_bf16 v[32:35], v[92:95], v[24:27], v[32:35]
    s_nop 0
    v_add_f32_dpp v36, v31, v36 row_ror:4 row_mask:0xf bank_mask:0x1
    s_waitcnt lgkmcnt(0)
    v_readfirstlane_b32 s68, v46
    s_cmp_eq_u32 s68, 1
    s_cbranch_scc1 L_k_h1
    s_cmp_eq_u32 s68, 2
    s_cbranch_scc1 L_k_h2
    s_cmp_eq_u32 s68, 3
    s_cbranch_scc1 L_k_h3
L_k_h0:
    s_waitcnt vmcnt(3)
    s_add_u32 s58, s57, 0x0
    buffer_load_dwordx4 v[64:67], v3, s[40:43], s58 offen nt
    v_add_u32 v61, 1, v61
    ds_write_b32 v63, v61
    v_mfma_f32_16x16x32_bf16 v[28:31], v[96:99], v[12:15], 0
    s_nop 6
    v_mov_b32_dpp v36, v32 row_ror:4 row_mask:0xf bank_mask:0x2
    s_waitcnt vmcnt(3)
    s_add_u32 s58, s57, 0x1000
    buffer_load_dwordx4 v[68:71], v3, s[40:43], s58 offen nt
    v_mfma_f32_16x16x32_bf16 v[28:31], v[100:103], v[16:19], v[28:31]
    s_nop 0
    v_add_f32_dpp v36, v33, v36 quad_perm:[0,1,2,3] row_mask:0xf bank_mask:0x2
    s_waitcnt vmcnt(3)
    s_add_u32 s58, s57, 0x2000
    buffer_load_dwordx4 v[72:75], v3, s[40:43], s58 offen nt
    v_add_u32 v61, 1, v61
    ds_write_b32 v63, v61
    v_mfma_f32_16x16x32_bf16 v[28:31], v[104:107], v[20:23], v[28:31]
    s_nop 0
    v_add_f32_dpp v36, v34, v36 row_ror:12 row_mask:0xf bank_mask:0x2
    s_waitcnt vmcnt(3)
    s_add_u32 s58, s57, 0x3000
    buffer_load_dwordx4 v[76:79], v3, s[40:43], s58 offen nt
    v_mfma_f32_16x16x32_bf16 v[28:31], v[108:111], v[24:27], v[28:31]
    s_nop 0
    v_add_f32_dpp v36, v35, v36 row_ror:8 row_mask:0xf bank_mask:0x2
    s_waitcnt vmcnt(3)
    s_add_u32 s58, s57, 0x4000
    buffer_load_dwordx4 v[80:83], v3, s[40:43], s58 offen nt
    v_add_u32 v61, 1, v61
    ds_write_b32 v63, v61
    v_mfma_f32_16x16x32_bf16 v[32:35], v[112:115], v[12:15], 0
    s_nop 6
    v_mov_b32_dpp v36, v28 row_ror:8 row_mask:0xf bank_mask:0x4
    s_waitcnt vmcnt(3)
    s_add_u32 s58, s57, 0x5000
    buffer_load_dwordx4 v[84:87], v3, s[40:43], s58 offen nt
    v_mfma_f32_16x16x32_bf16 v[32:35], v[116:119], v[16:19], v[32:35]
    s_nop 0
    v_add_f32_dpp v36, v29, v36 row_ror:4 row_mask:0xf bank_mask:0x4
    s_waitcnt vmcnt(3)
    s_add_u32 s58, s57, 0x6000
    buffer_load_dwordx4 v[88:91], v3, s[40:43], s58 offen nt
    v_add_u32 v61, 1, v61
    ds_write_b32 v63, v61
    ds_read_b32 v46, v63 offset:16
    v_mfma_f32_16x16x32_bf16 v[32:35], v[120:123], v[20:23], v[32:35]
    s_nop 0
    v_add_f32_dpp v36, v30, v36 quad_perm:[0,1,2,3] row_mask:0xf bank_mask:0x4
    s_waitcnt vmcnt(3)
    s_add_u32 s58, s57, 0x7000
    buffer_load_dwordx4 v[92:95], v3, s[40:43], s58 offen nt
    v_mfma_f32_16x16x32_bf16 v[32:35], v[124:127], v[24:27], v[32:35]
    s_nop 0
    v_add_f32_dpp v36, v31, v36 row_ror:12 row_mask:0xf bank_mask:0x4
    s_nop 7
    v_mov_b32_dpp v36, v32 row_ror:12 row_mask:0xf bank_mask:0x8
    s_nop 1
    v_add_f32_dpp v36, v33, v36 row_ror:8 row_mask:0xf bank_mask:0x8
    s_nop 1
    v_add_f32_dpp v36, v34, v36 row_ror:4 row_mask:0xf bank_mask:0x8
    s_nop 1
    v_add_f32_dpp v36, v35, v36 quad_perm:[0,1,2,3] row_mask:0xf bank_mask:0x8
    s_nop 1
    v_cvt_pk_bf16_f32 v38, v36, v36
    v_and_b32 v36, 0xffff0000, v38
    v_mul_f32 v39, 0x3db504f3, v36
    v_cvt_pk_bf16_f32 v38, v39, v39
    v_and_b32 v39, 0xffff0000, v38
    v_max_f32 v37, v37, v39
    ds_write_b32 v59, v39
    v_add_u32 v59, 256, v59
    s_branch L_k_e
L_k_b1:
    s_waitcnt vmcnt(4)
    s_add_u32 s58, s56, 0x10000
    buffer_load_dwordx4 v[96:99], v2, s[36:39], s58 offen nt
    v_add_u32 v61, 1, v61
    ds_write_b32 v63, v61
    v_mfma_f32_16x16x32_bf16 v[28:31], v[64:67], v[12:15], 0
    s_waitcnt vmcnt(4)
    s_add_u32 s58, s56, 0x11000
    buffer_load_dwordx4 v[100:103], v2, s[36:39], s58 offen nt
    v_mfma_f32_16x16x32_bf16 v[28:31], v[68:71], v[16:19], v[28:31]
    s_waitcnt vmcnt(4)
    s_add_u32 s58, s56, 0x12000
    buffer_load_dwordx4 v[104:107], v2, s[36:39], s58 offen nt
    v_add_u32 v61, 1, v61
    ds_write_b32 v63, v61
    v_mfma_f32_16x16x32_bf16 v[28:31], v[72:75], v[20:23], v[28:31]
    s_waitcnt vmcnt(4)
    s_add_u32 s58, s56, 0x13000
    buffer_load_dwordx4 v[108:111], v2, s[36:39], s58 offen nt
    v_mfma_f32_16x16x32_bf16 v[28:31], v[76:79], v[24:27], v[28:31]
    s_waitcnt vmcnt(4)
    s_add_u32 s58, s56, 0x14000
    buffer_load_dwordx4 v[112:115], v2, s[36:39], s58 offen nt
    v_add_u32 v61, 1, v61
    ds_write_b32 v63, v61
    v_mfma_f32_16x16x32_bf16 v[32:35], v[80:83], v[12:15], 0
    s_nop 6
    v_mov_b32_dpp v36, v28 quad_perm:[0,1,2,3] row_mask:0xf bank_mask:0x1
    s_waitcnt vmcnt(4)
    s_add_u32 s58, s56, 0x15000
    buffer_load_dwordx4 v[116:119], v2, s[36:39], s58 offen nt
    v_mfma_f32_16x16x32_bf16 v[32:35], v[84:87], v[16:19], v[32:35]
    s_nop 0
    v_add_f32_dpp v36, v29, v36 row_ror:12 row_mask:0xf bank_mask:0x1
    s_waitcnt vmcnt(4)
    s_add_u32 s58, s56, 0x16000
    buffer_load_dwordx4 v[120:123], v2, s[36:39], s58 offen nt
    v_add_u32 v61, 1, v61
    ds_write_b32 v63, v61
    ds_read_b32 v46, v63 offset:16
    v_mfma_f32_16x16x32_bf16 v[32:35], v[88:91], v[20:23], v[32:35]
    s_nop 0
    v_add_f32_dpp v36, v30, v36 row_ror:8 row_mask:0xf bank_mask:0x1
    s_waitcnt vmcnt(4)
    s_add_u32 s58, s56, 0x17000
    buffer_load_dwordx4 v[124:127], v2, s[36:39], s58 offen nt
    v_mfma_f32_16x16x32_bf16 v[32:35], v[92:95], v[24:27], v[32:35]
    s_nop 0
    v_add_f32_dpp v36, v31, v36 row_ror:4 row_mask:0xf bank_mask:0x1
    s_waitcnt lgkmcnt(0)
    v_readfirstlane_b32 s68, v46
    s_cmp_eq_u32 s68, 0
    s_cbranch_scc1 L_k_h0
    s_cmp_eq_u32 s68, 2
    s_cbranch_scc1 L_k_h2
    s_cmp_eq_u32 s68, 3
    s_cbranch_scc1 L_k_h3
L_k_h1:
    s_waitcnt vmcnt(4)
    s_add_u32 s58, s57, 0x0
    buffer_load_dwordx4 v[64:67], v3, s[40:43], s58 offen nt
    v_add_u32 v61, 1, v61
    ds_write_b32 v63, v61
    v_mfma_f32_16x16x32_bf16 v[28:31], v[96:99], v[12:15], 0
    s_nop 6
    v_mov_b32_dpp v36, v32 row_ror:4 row_mask:0xf bank_mask:0x2
    s_waitcnt vmcnt(4)
    s_add_u32 s58, s57, 0x1000
    buffer_load_dwordx4 v[68:71], v3, s[40:43], s58 offen nt
    v_mfma_f32_16x16x32_bf16 v[28:31], v[100:103], v[16:19], v[28:31]
    s_nop 0
    v_add_f32_dpp v36, v33, v36 quad_perm:[0,1,2,3] row_mask:0xf bank_mask:0x2
    s_waitcnt vmcnt(4)
    s_add_u32 s58, s57, 0x2000
    buffer_load_dwordx4 v[72:75], v3, s[40:43], s58 offen nt
    v_add_u32 v61, 1, v61
    ds_write_b32 v63, v61
    v_mfma_f32_16x16x32_bf16 v[28:31], v[104:107], v[20:23], v[28:31]
    s_nop 0
    v_add_f32_dpp v36, v34, v36 row_ror:12 row_mask:0xf bank_mask:0x2
    s_waitcnt vmcnt(4)
    s_add_u32 s58, s57, 0x3000
    buffer_load_dwordx4 v[76:79], v3, s[40:43], s58 offen nt
    v_mfma_f32_16x16x32_bf16 v[28:31], v[108:111], v[24:27], v[28:31]
    s_nop 0
    v_add_f32_dpp v36, v35, v36 row_ror:8 row_mask:0xf bank_mask:0x2
    s_waitcnt vmcnt(4)
    s_add_u32 s58, s57, 0x4000
    buffer_load_dwordx4 v[80:83], v3, s[40:43], s58 offen nt
    v_add_u32 v61, 1, v61
    ds_write_b32 v63, v61
    v_mfma_f32_16x16x32_bf16 v[32:35], v[112:115], v[12:15], 0
    s_nop 6
    v_mov_b32_dpp v36, v28 row_ror:8 row_mask:0xf bank_mask:0x4
    s_waitcnt vmcnt(4)
    s_add_u32 s58, s57, 0x5000
    buffer_load_dwordx4 v[84:87], v3, s[40:43], s58 offen nt
    v_mfma_f32_16x16x32_bf16 v[32:35], v[116:119], v[16:19], v[32:35]
    s_nop 0
    v_add_f32_dpp v36, v29, v36 row_ror:4 row_mask:0xf bank_mask:0x4
    s_waitcnt vmcnt(4)
    s_add_u32 s58, s57, 0x6000
    buffer_load_dwordx4 v[88:91], v3, s[40:43], s58 offen nt
    v_add_u32 v61, 1, v61
    ds_write_b32 v63, v61
    ds_read_b32 v46, v63 offset:16
    v_mfma_f32_16x16x32_bf16 v[32:35], v[120:123], v[20:23], v[32:35]
    s_nop 0
    v_add_f32_dpp v36, v30, v36 quad_perm:[0,1,2,3] row_mask:0xf bank_mask:0x4
    s_waitcnt vmcnt(4)
    s_add_u32 s58, s57, 0x7000
    buffer_load_dwordx4 v[92:95], v3, s[40:43], s58 offen nt
    v_mfma_f32_16x16x32_bf16 v[32:35], v[124:127], v[24:27], v[32:35]
    s_nop 0
    v_add_f32_dpp v36, v31, v36 row_ror:12 row_mask:0xf bank_mask:0x4
    s_nop 7
    v_mov_b32_dpp v36, v32 row_ror:12 row_mask:0xf bank_mask:0x8
    s_nop 1
    v_add_f32_dpp v36, v33, v36 row_ror:8 row_mask:0xf bank_mask:0x8
    s_nop 1
    v_add_f32_dpp v36, v34, v36 row_ror:4 row_mask:0xf bank_mask:0x8
    s_nop 1
    v_add_f32_dpp v36, v35, v36 quad_perm:[0,1,2,3] row_mask:0xf bank_mask:0x8
    s_nop 1
    v_cvt_pk_bf16_f32 v38, v36, v36
    v_and_b32 v36, 0xffff0000, v38
    v_mul_f32 v39, 0x3db504f3, v36
    v_cvt_pk_bf16_f32 v38, v39, v39
    v_and_b32 v39, 0xffff0000, v38
    v_max_f32 v37, v37, v39
    ds_write_b32 v59, v39
    v_add_u32 v59, 256, v59
    s_branch L_k_e
L_k_b2:
    s_waitcnt vmcnt(5)
    s_add_u32 s58, s56, 0x10000
    buffer_load_dwordx4 v[96:99], v2, s[36:39], s58 offen nt
    v_add_u32 v61, 1, v61
    ds_write_b32 v63, v61
    v_mfma_f32_16x16x32_bf16 v[28:31], v[64:67], v[12:15], 0
    s_waitcnt vmcnt(5)
    s_add_u32 s58, s56, 0x11000
    buffer_load_dwordx4 v[100:103], v2, s[36:39], s58 offen nt
    v_mfma_f32_16x16x32_bf16 v[28:31], v[68:71], v[16:19], v[28:31]
    s_waitcnt vmcnt(5)
    s_add_u32 s58, s56, 0x12000
    buffer_load_dwordx4 v[104:107], v2, s[36:39], s58 offen nt
    v_add_u32 v61, 1, v61
    ds_write_b32 v63, v61
    v_mfma_f32_16x16x32_bf16 v[28:31], v[72:75], v[20:23], v[28:31]
    s_waitcnt vmcnt(5)
    s_add_u32 s58, s56, 0x13000
    buffer_load_dwordx4 v[108:111], v2, s[36:39], s58 offen nt
    v_mfma_f32_16x16x32_bf16 v[28:31], v[76:79], v[24:27], v[28:31]
    s_waitcnt vmcnt(5)
    s_add_u32 s58, s56, 0x14000
    buffer_load_dwordx4 v[112:115], v2, s[36:39], s58 offen nt
    v_add_u32 v61, 1, v61
    ds_write_b32 v63, v61
    v_mfma_f32_16x16x32_bf16 v[32:35], v[80:83], v[12:15], 0
    s_nop 6
    v_mov_b32_dpp v36, v28 quad_perm:[0,1,2,3] row_mask:0xf bank_mask:0x1
    s_waitcnt vmcnt(5)
    s_add_u32 s58, s56, 0x15000
    buffer_load_dwordx4 v[116:119], v2, s[36:39], s58 offen nt
    v_mfma_f32_16x16x32_bf16 v[32:35], v[84:87], v[16:19], v[32:35]
    s_nop 0
    v_add_f32_dpp v36, v29, v36 row_ror:12 row_mask:0xf bank_mask:0x1
    s_waitcnt vmcnt(5)
    s_add_u32 s58, s56, 0x16000
    buffer_load_dwordx4 v[120:123], v2, s[36:39], s58 offen nt
    v_add_u32 v61, 1, v61
    ds_write_b32 v63, v61
    ds_read_b32 v46, v63 offset:16
    v_mfma_f32_16x16x32_bf16 v[32:35], v[88:91], v[20:23], v[32:35]
    s_nop 0
    v_add_f32_dpp v36, v30, v36 row_ror:8 row_mask:0xf bank_mask:0x1
    s_waitcnt vmcnt(5)
    s_add_u32 s58, s56, 0x17000
    buffer_load_dwordx4 v[124:127], v2, s[36:39], s58 offen nt
    v_mfma_f32_16x16x32_bf16 v[32:35], v[92:95], v[24:27], v[32:35]
    s_nop 0
    v_add_f32_dpp v36, v31, v36 row_ror:4 row_mask:0xf bank_mask:0x1
    s_waitcnt lgkmcnt(0)
    v_readfirstlane_b32 s68, v46
    s_cmp_eq_u32 s68, 0
    s_cbranch_scc1 L_k_h0
    s_cmp_eq_u32 s68, 1
    s_cbranch_scc1 L_k_h1
    s_cmp_eq_u32 s68, 3
    s_cbranch_scc1 L_k_h3
L_k_h2:
    s_waitcnt vmcnt(5)
    s_add_u32 s58, s57, 0x0
    buffer_load_dwordx4 v[64:67], v3, s[40:43], s58 offen nt
    v_add_u32 v61, 1, v61
    ds_write_b32 v63, v61
    v_mfma_f32_16x16x32_bf16 v[28:31], v[96:99], v[12:15], 0
    s_nop 6
    v_mov_b32_dpp v36, v32 row_ror:4 row_mask:0xf bank_mask:0x2
    s_waitcnt vmcnt(5)
    s_add_u32 s58, s57, 0x1000
    buffer_load_dwordx4 v[68:71], v3, s[40:43], s58 offen nt
    v_mfma_f32_16x16x32_bf16 v[28:31], v[100:103], v[16:19], v[28:31]
    s_nop 0
    v_add_f32_dpp v36, v33, v36 quad_perm:[0,1,2,3] row_mask:0xf bank_mask:0x2
    s_waitcnt vmcnt(5)
    s_add_u32 s58, s57, 0x2000
    buffer_load_dwordx4 v[72:75], v3, s[40:43], s58 offen nt
    v_add_u32 v61, 1, v61
    ds_write_b32 v63, v61
    v_mfma_f32_16x16x32_bf16 v[28:31], v[104:107], v[20:23], v[28:31]
    s_nop 0
    v_add_f32_dpp v36, v34, v36 row_ror:12 row_mask:0xf bank_mask:0x2
    s_waitcnt vmcnt(5)
    s_add_u32 s58, s57, 0x3000
    buffer_load_dwordx4 v[76:79], v3, s[40:43], s58 offen nt
    v_mfma_f32_16x16x32_bf16 v[28:31], v[108:111], v[24:27], v[28:31]
    s_nop 0
    v_add_f32_dpp v36, v35, v36 row_ror:8 row_mask:0xf bank_mask:0x2
    s_waitcnt vmcnt(5)
    s_add_u32 s58, s57, 0x4000
    buffer_load_dwordx4 v[80:83], v3, s[40:43], s58 offen nt
    v_add_u32 v61, 1, v61
    ds_write_b32 v63, v61
    v_mfma_f32_16x16x32_bf16 v[32:35], v[112:115], v[12:15], 0
    s_nop 6
    v_mov_b32_dpp v36, v28 row_ror:8 row_mask:0xf bank_mask:0x4
    s_waitcnt vmcnt(5)
    s_add_u32 s58, s57, 0x5000
    buffer_load_dwordx4 v[84:87], v3, s[40:43], s58 offen nt
    v_mfma_f32_16x16x32_bf16 v[32:35], v[116:119], v[16:19], v[32:35]
    s_nop 0
    v_add_f32_dpp v36, v29, v36 row_ror:4 row_mask:0xf bank_mask:0x4
    s_waitcnt vmcnt(5)
    s_add_u32 s58, s57, 0x6000
    buffer_load_dwordx4 v[88:91], v3, s[40:43], s58 offen nt
    v_add_u32 v61, 1, v61
    ds_write_b32 v63, v61
    ds_read_b32 v46, v63 offset:16
    v_mfma_f32_16x16x32_bf16 v[32:35], v[120:123], v[20:23], v[32:35]
    s_nop 0
    v_add_f32_dpp v36, v30, v36 quad_perm:[0,1,2,3] row_mask:0xf bank_mask:0x4
    s_waitcnt vmcnt(5)
    s_add_u32 s58, s57, 0x7000
    buffer_load_dwordx4 v[92:95], v3, s[40:43], s58 offen nt
    v_mfma_f32_16x16x32_bf16 v[32:35], v[124:127], v[24:27], v[32:35]
    s_nop 0
    v_add_f32_dpp v36, v31, v36 row_ror:12 row_mask:0xf bank_mask:0x4
    s_nop 7
    v_mov_b32_dpp v36, v32 row_ror:12 row_mask:0xf bank_mask:0x8
    s_nop 1
    v_add_f32_dpp v36, v33, v36 row_ror:8 row_mask:0xf bank_mask:0x8
    s_nop 1
    v_add_f32_dpp v36, v34, v36 row_ror:4 row_mask:0xf bank_mask:0x8
    s_nop 1
    v_add_f32_dpp v36, v35, v36 quad_perm:[0,1,2,3] row_mask:0xf bank_mask:0x8
    s_nop 1
    v_cvt_pk_bf16_f32 v38, v36, v36
    v_and_b32 v36, 0xffff0000, v38
    v_mul_f32 v39, 0x3db504f3, v36
    v_cvt_pk_bf16_f32 v38, v39, v39
    v_and_b32 v39, 0xffff0000, v38
    v_max_f32 v37, v37, v39
    ds_write_b32 v59, v39
    v_add_u32 v59, 256, v59
    s_branch L_k_e
L_k_b3:
    s_waitcnt vmcnt(6)
    s_add_u32 s58, s56, 0x10000
    buffer_load_dwordx4 v[96:99], v2, s[36:39], s58 offen nt
    v_add_u32 v61, 1, v61
    ds_write_b32 v63, v61
    v_mfma_f32_16x16x32_bf16 v[28:31], v[64:67], v[12:15], 0
    s_waitcnt vmcnt(6)
    s_add_u32 s58, s56, 0x11000
    buffer_load_dwordx4 v[100:103], v2, s[36:39], s58 offen nt
    v_mfma_f32_16x16x32_bf16 v[28:31], v[68:71], v[16:19], v[28:31]
    s_waitcnt vmcnt(6)
    s_add_u32 s58, s56, 0x12000
    buffer_load_dwordx4 v[104:107], v2, s[36:39], s58 offen nt
    v_add_u32 v61, 1, v61
    ds_write_b32 v63, v61
    v_mfma_f32_16x16x32_bf16 v[28:31], v[72:75], v[20:23], v[28:31]
    s_waitcnt vmcnt(6)
    s_add_u32 s58, s56, 0x13000
    buffer_load_dwordx4 v[108:111], v2, s[36:39], s58 offen nt
    v_mfma_f32_16x16x32_bf16 v[28:31], v[76:79], v[24:27], v[28:31]
    s_waitcnt vmcnt(6)
    s_add_u32 s58, s56, 0x14000
    buffer_load_dwordx4 v[112:115], v2, s[36:39], s58 offen nt
    v_add_u32 v61, 1, v61
    ds_write_b32 v63, v61
    v_mfma_f32_16x16x32_bf16 v[32:35], v[80:83], v[12:15], 0
    s_nop 6
    v_mov_b32_dpp v36, v28 quad_perm:[0,1,2,3] row_mask:0xf bank_mask:0x1
    s_waitcnt vmcnt(6)
    s_add_u32 s58, s56, 0x15000
    buffer_load_dwordx4 v[116:119], v2, s[36:39], s58 offen nt
    v_mfma_f32_16x16x32_bf16 v[32:35], v[84:87], v[16:19], v[32:35]
    s_nop 0
    v_add_f32_dpp v36, v29, v36 row_ror:12 row_mask:0xf bank_mask:0x1
    s_waitcnt vmcnt(6)
    s_add_u32 s58, s56, 0x16000
    buffer_load_dwordx4 v[120:123], v2, s[36:39], s58 offen nt
    v_add_u32 v61, 1, v61
    ds_write_b32 v63, v61
    ds_read_b32 v46, v63 offset:16
    v_mfma_f32_16x16x32_bf16 v[32:35], v[88:91], v[20:23], v[32:35]
    s_nop 0
    v_add_f32_dpp v36, v30, v36 row_ror:8 row_mask:0xf bank_mask:0x1
    s_waitcnt vmcnt(6)
    s_add_u32 s58, s56, 0x17000
    buffer_load_dwordx4 v[124:127], v2, s[36:39], s58 offen nt
    v_mfma_f32_16x16x32_bf16 v[32:35], v[92:95], v[24:27], v[32:35]
    s_nop 0
    v_add_f32_dpp v36, v31, v36 row_ror:4 row_mask:0xf bank_mask:0x1
    s_waitcnt lgkmcnt(0)
    v_readfirstlane_b32 s68, v46
    s_cmp_eq_u32 s68, 0
    s_cbranch_scc1 L_k_h0
    s_cmp_eq_u32 s68, 1
    s_cbranch_scc1 L_k_h1
    s_cmp_eq_u32 s68, 2
    s_cbranch_scc1 L_k_h2
L_k_h3:
    s_waitcnt vmcnt(6)
    s_add_u32 s58, s57, 0x0
    buffer_load_dwordx4 v[64:67], v3, s[40:43], s58 offen nt
    v_add_u32 v61, 1, v61
    ds_write_b32 v63, v61
    v_mfma_f32_16x16x32_bf16 v[28:31], v[96:99], v[12:15], 0
    s_nop 6
    v_mov_b32_dpp v36, v32 row_ror:4 row_mask:0xf bank_mask:0x2
    s_waitcnt vmcnt(6)
    s_add_u32 s58, s57, 0x1000
    buffer_load_dwordx4 v[68:71], v3, s[40:43], s58 offen nt
    v_mfma_f32_16x16x32_bf16 v[28:31], v[100:103], v[16:19], v[28:31]
    s_nop 0
    v_add_f32_dpp v36, v33, v36 quad_perm:[0,1,2,3] row_mask:0xf bank_mask:0x2
    s_waitcnt vmcnt(6)
    s_add_u32 s58, s57, 0x2000
    buffer_load_dwordx4 v[72:75], v3, s[40:43], s58 offen nt
    v_add_u32 v61, 1, v61
    ds_write_b32 v63, v61
    v_mfma_f32_16x16x32_bf16 v[28:31], v[104:107], v[20:23], v[28:31]
    s_nop 0
    v_add_f32_dpp v36, v34, v36 row_ror:12 row_mask:0xf bank_mask:0x2
    s_waitcnt vmcnt(6)
    s_add_u32 s58, s57, 0x3000
    buffer_load_dwordx4 v[76:79], v3, s[40:43], s58 offen nt
    v_mfma_f32_16x16x32_bf16 v[28:31], v[108:111], v[24:27], v[28:31]
    s_nop 0
    v_add_f32_dpp v36, v35, v36 row_ror:8 row_mask:0xf bank_mask:0x2
    s_waitcnt vmcnt(6)
    s_add_u32 s58, s57, 0x4000
    buffer_load_dwordx4 v[80:83], v3, s[40:43], s58 offen nt
    v_add_u32 v61, 1, v61
    ds_write_b32 v63, v61
    v_mfma_f32_16x16x32_bf16 v[32:35], v[112:115], v[12:15], 0
    s_nop 6
    v_mov_b32_dpp v36, v28 row_ror:8 row_mask:0xf bank_mask:0x4
    s_waitcnt vmcnt(6)
    s_add_u32 s58, s57, 0x5000
    buffer_load_dwordx4 v[84:87], v3, s[40:43], s58 offen nt
    v_mfma_f32_16x16x32_bf16 v[32:35], v[116:119], v[16:19], v[32:35]
    s_nop 0
    v_add_f32_dpp v36, v29, v36 row_ror:4 row_mask:0xf bank_mask:0x4
    s_waitcnt vmcnt(6)
    s_add_u32 s58, s57, 0x6000
    buffer_load_dwordx4 v[88:91], v3, s[40:43], s58 offen nt
    v_add_u32 v61, 1, v61
    ds_write_b32 v63, v61
    ds_read_b32 v46, v63 offset:16
    v_mfma_f32_16x16x32_bf16 v[32:35], v[120:123], v[20:23], v[32:35]
    s_nop 0
    v_add_f32_dpp v36, v30, v36 quad_perm:[0,1,2,3] row_mask:0xf bank_mask:0x4
    s_waitcnt vmcnt(6)
    s_add_u32 s58, s57, 0x7000
    buffer_load_dwordx4 v[92:95], v3, s[40:43], s58 offen nt
    v_mfma_f32_16x16x32_bf16 v[32:35], v[124:127], v[24:27], v[32:35]
    s_nop 0
    v_add_f32_dpp v36, v31, v36 row_ror:12 row_mask:0xf bank_mask:0x4
    s_nop 7
    v_mov_b32_dpp v36, v32 row_ror:12 row_mask:0xf bank_mask:0x8
    s_nop 1
    v_add_f32_dpp v36, v33, v36 row_ror:8 row_mask:0xf bank_mask:0x8
    s_nop 1
    v_add_f32_dpp v36, v34, v36 row_ror:4 row_mask:0xf bank_mask:0x8
    s_nop 1
    v_add_f32_dpp v36, v35, v36 quad_perm:[0,1,2,3] row_mask:0xf bank_mask:0x8
    s_nop 1
    v_cvt_pk_bf16_f32 v38, v36, v36
    v_and_b32 v36, 0xffff0000, v38
    v_mul_f32 v39, 0x3db504f3, v36
    v_cvt_pk_bf16_f32 v38, v39, v39
    v_and_b32 v39, 0xffff0000, v38
    v_max_f32 v37, v37, v39
    ds_write_b32 v59, v39
    v_add_u32 v59, 256, v59
L_k_e:
    s_mov_b32 s56, s57
    s_add_u32 s59, s59, 1
    s_cmp_lt_u32 s59, 16
    s_cbranch_scc1 L_kloop
    s_mov_b32 s36, s8
    s_mov_b32 s37, s9
    v_mov_b32 v2, v4
    s_waitcnt vmcnt(4)
    s_add_u32 s58, s56, 0x10000
    buffer_load_dwordx4 v[96:99], v2, s[36:39], s58 offen nt
    v_add_u32 v61, 1, v61
    ds_write_b32 v63, v61
    s_waitcnt lgkmcnt(0)
    ds_read2st64_b32 v[128:129], v58 offset0:0 offset1:1
    ds_read2st64_b32 v[130:131], v58 offset0:2 offset1:3
    ds_read2st64_b32 v[132:133], v58 offset0:4 offset1:5
    ds_read2st64_b32 v[134:135], v58 offset0:6 offset1:7
    ds_read2st64_b32 v[136:137], v58 offset0:8 offset1:9
    ds_read2st64_b32 v[138:139], v58 offset0:10 offset1:11
    ds_read2st64_b32 v[140:141], v58 offset0:12 offset1:13
    ds_read2st64_b32 v[142:143], v58 offset0:14 offset1:15
    s_nop 1
    v_max_f32_dpp v37, v37, v37 row_ror:8 row_mask:0xf bank_mask:0xf
    s_nop 1
    v_max_f32_dpp v37, v37, v37 row_ror:4 row_mask:0xf bank_mask:0xf
    s_nop 1
    v_max_f32_dpp v37, v37, v37 row_ror:2 row_mask:0xf bank_mask:0xf
    s_nop 1
    v_max_f32_dpp v37, v37, v37 row_ror:1 row_mask:0xf bank_mask:0xf
    s_nop 0
    v_mov_b32 v38, v37
    s_nop 1
    v_permlane16_swap_b32 v37, v38
    s_nop 0
    v_max_f32 v37, v37, v38
    s_nop 0
    v_mov_b32 v38, v37
    s_nop 1
    v_permlane32_swap_b32 v37, v38
    s_nop 0
    v_max_f32 v37, v37, v38
    s_mov_b32 s60, 0x3fb8aa3b
    s_waitcnt lgkmcnt(0)
    v_sub_f32 v128, v128, v37
    v_sub_f32 v129, v129, v37
    v_sub_f32 v130, v130, v37
    v_sub_f32 v131, v131, v37
    v_sub_f32 v132, v132, v37
    v_sub_f32 v133, v133, v37
    v_sub_f32 v134, v134, v37
    v_sub_f32 v135, v135, v37
    v_sub_f32 v136, v136, v37
    v_sub_f32 v137, v137, v37
    v_sub_f32 v138, v138, v37
    v_sub_f32 v139, v139, v37
    v_sub_f32 v140, v140, v37
    v_sub_f32 v141, v141, v37
    v_sub_f32 v142, v142, v37
    v_sub_f32 v143, v143, v37
    s_waitcnt vmcnt(4)
    s_add_u32 s58, s56, 0x11000
    buffer_load_dwordx4 v[100:103], v2, s[36:39], s58 offen nt
    v_mul_f32 v128, s60, v128
    v_mul_f32 v129, s60, v129
    v_mul_f32 v130, s60, v130
    v_mul_f32 v131, s60, v131
    v_mul_f32 v132, s60, v132
    v_mul_f32 v133, s60, v133
    v_mul_f32 v134, s60, v134
    v_mul_f32 v135, s60, v135
    v_mul_f32 v136, s60, v136
    v_mul_f32 v137, s60, v137
    v_mul_f32 v138, s60, v138
    v_mul_f32 v139, s60, v139
    v_mul_f32 v140, s60, v140
    v_mul_f32 v141, s60, v141
    v_mul_f32 v142, s60, v142
    v_mul_f32 v143, s60, v143
    v_exp_f32 v128, v128
    v_exp_f32 v129, v129
    v_exp_f32 v130, v130
    v_exp_f32 v131, v131
    v_exp_f32 v132, v132
    v_exp_f32 v133, v133
    v_exp_f32 v134, v134
    v_exp_f32 v135, v135
    v_exp_f32 v136, v136
    v_exp_f32 v137, v137
    v_exp_f32 v138, v138
    v_exp_f32 v139, v139
    v_exp_f32 v140, v140
    v_exp_f32 v141, v141
    v_exp_f32 v142, v142
    v_exp_f32 v143, v143
    s_nop 0
    v_cvt_pk_bf16_f32 v144, v128, v128
    v_cvt_pk_bf16_f32 v145, v129, v129
    v_cvt_pk_bf16_f32 v146, v130, v130
    v_cvt_pk_bf16_f32 v147, v131, v131
    v_cvt_pk_bf16_f32 v148, v132, v132
    v_cvt_pk_bf16_f32 v149, v133, v133
    v_cvt_pk_bf16_f32 v150, v134, v134
    v_cvt_pk_bf16_f32 v151, v135, v135
    v_cvt_pk_bf16_f32 v152, v136, v136
    v_cvt_pk_bf16_f32 v153, v137, v137
    v_cvt_pk_bf16_f32 v154, v138, v138
    v_cvt_pk_bf16_f32 v155, v139, v139
    v_cvt_pk_bf16_f32 v156, v140, v140
    v_cvt_pk_bf16_f32 v157, v141, v141
    v_cvt_pk_bf16_f32 v158, v142, v142
    v_cvt_pk_bf16_f32 v159, v143, v143
    ds_write2st64_b32 v58, v144, v145 offset0:0 offset1:1
    ds_write2st64_b32 v58, v146, v147 offset0:2 offset1:3
    ds_write2st64_b32 v58, v148, v149 offset0:4 offset1:5
    ds_write2st64_b32 v58, v150, v151 offset0:6 offset1:7
    ds_write2st64_b32 v58, v152, v153 offset0:8 offset1:9
    ds_write2st64_b32 v58, v154, v155 offset0:10 offset1:11
    ds_write2st64_b32 v58, v156, v157 offset0:12 offset1:13
    ds_write2st64_b32 v58, v158, v159 offset0:14 offset1:15
    v_mov_b32 v57, v144
    s_waitcnt vmcnt(4)
    s_add_u32 s58, s56, 0x12000
    buffer_load_dwordx4 v[104:107], v2, s[36:39], s58 offen nt
    v_add_u32 v61, 1, v61
    ds_write_b32 v63, v61
    v_add_f32 v128, v128, v136
    v_add_f32 v129, v129, v137
    v_add_f32 v130, v130, v138
    v_add_f32 v131, v131, v139
    v_add_f32 v132, v132, v140
    v_add_f32 v133, v133, v141
    v_add_f32 v134, v134, v142
    v_add_f32 v135, v135, v143
    v_add_f32 v128, v128, v132
    v_add_f32 v129, v129, v133
    v_add_f32 v130, v130, v134
    v_add_f32 v131, v131, v135
    v_add_f32 v128, v128, v130
    v_add_f32 v129, v129, v131
    v_add_f32 v128, v128, v129
    s_nop 1
    v_add_f32_dpp v128, v128, v128 row_ror:8 row_mask:0xf bank_mask:0xf
    s_nop 1
    v_add_f32_dpp v128, v128, v128 row_ror:4 row_mask:0xf bank_mask:0xf
    s_nop 1
    v_add_f32_dpp v128, v128, v128 row_ror:2 row_mask:0xf bank_mask:0xf
    s_nop 1
    v_add_f32_dpp v128, v128, v128 row_ror:1 row_mask:0xf bank_mask:0xf
    s_nop 0
    v_mov_b32 v38, v128
    s_nop 1
    v_permlane16_swap_b32 v128, v38
    s_nop 0
    v_add_f32 v128, v128, v38
    s_nop 0
    v_mov_b32 v38, v128
    s_nop 1
    v_permlane32_swap_b32 v128, v38
    s_nop 0
    v_add_f32 v128, v128, v38
    v_mov_b32 v38, v37
    v_mov_b32 v39, v128
    s_lshl_b32 s60, s28, 3
    s_add_u32 s60, s60, 272
    v_mov_b32 v40, s60
    v_mov_b32 v41, 320
    v_mov_b32 v42, 1
    s_mov_b64 exec, 1
    ds_write_b64 v40, v[38:39]
    s_waitcnt lgkmcnt(0)
    ds_add_u32 v41, v42
    s_mov_b64 exec, -1
    v_mov_b32 v45, 16
    v_mov_b32 v28, 0
    v_mov_b32 v29, 0
    v_mov_b32 v30, 0
    v_mov_b32 v31, 0
    v_add_u32 v59, 256, v58
    v_lshlrev_b32 v43, 4, v6
    v_lshlrev_b32 v44, 3, v5
    s_mul_i32 s60, s28, 320
    v_add3_u32 v60, v43, v44, s60
    s_mov_b32 s59, 0
    s_add_u32 s57, s56, 0x20000
    s_waitcnt lgkmcnt(0)
    v_mov_b32 v56, v57
    ds_read_b32 v57, v59
    v_add_u32 v59, 256, v59
    v_and_b32_dpp v48, v56, v8 row_newbcast:0 row_mask:0xf bank_mask:0xf
    v_and_b32_dpp v49, v56, v9 row_newbcast:0 row_mask:0xf bank_mask:0xf
    v_and_b32_dpp v50, v56, v10 row_newbcast:0 row_mask:0xf bank_mask:0xf
    v_and_b32_dpp v51, v56, v11 row_newbcast:0 row_mask:0xf bank_mask:0xf
    v_and_b32_dpp v52, v56, v8 row_newbcast:1 row_mask:0xf bank_mask:0xf
    v_and_b32_dpp v53, v56, v9 row_newbcast:1 row_mask:0xf bank_mask:0xf
    v_and_b32_dpp v54, v56, v10 row_newbcast:1 row_mask:0xf bank_mask:0xf
    v_and_b32_dpp v55, v56, v11 row_newbcast:1 row_mask:0xf bank_mask:0xf
    s_waitcnt vmcnt(10)
    v_mfma_f32_16x16x32_bf16 v[28:31], v[48:51], v[64:67], v[28:31]
    v_and_b32_dpp v48, v56, v8 row_newbcast:2 row_mask:0xf bank_mask:0xf
    v_and_b32_dpp v49, v56, v9 row_newbcast:2 row_mask:0xf bank_mask:0xf
    v_and_b32_dpp v50, v56, v10 row_newbcast:2 row_mask:0xf bank_mask:0xf
    v_and_b32_dpp v51, v56, v11 row_newbcast:2 row_mask:0xf bank_mask:0xf
    s_waitcnt vmcnt(9)
    v_mfma_f32_16x16x32_bf16 v[28:31], v[52:55], v[68:71], v[28:31]
    v_and_b32_dpp v52, v56, v8 row_newbcast:3 row_mask:0xf bank_mask:0xf
    v_and_b32_dpp v53, v56, v9 row_newbcast:3 row_mask:0xf bank_mask:0xf
    v_and_b32_dpp v54, v56, v10 row_newbcast:3 row_mask:0xf bank_mask:0xf
    v_and_b32_dpp v55, v56, v11 row_newbcast:3 row_mask:0xf bank_mask:0xf
    s_waitcnt vmcnt(8)
    v_mfma_f32_16x16x32_bf16 v[28:31], v[48:51], v[72:75], v[28:31]
    v_and_b32_dpp v48, v56, v8 row_newbcast:4 row_mask:0xf bank_mask:0xf
    v_and_b32_dpp v49, v56, v9 row_newbcast:4 row_mask:0xf bank_mask:0xf
    v_and_b32_dpp v50, v56, v10 row_newbcast:4 row_mask:0xf bank_mask:0xf
    v_and_b32_dpp v51, v56, v11 row_newbcast:4 row_mask:0xf bank_mask:0xf
    s_waitcnt vmcnt(4)
    v_mfma_f32_16x16x32_bf16 v[28:31], v[52:55], v[76:79], v[28:31]
    s_add_u32 s58, s56, 0x13000
    buffer_load_dwordx4 v[108:111], v2, s[36:39], s58 offen nt
    v_and_b32_dpp v52, v56, v8 row_newbcast:5 row_mask:0xf bank_mask:0xf
    v_and_b32_dpp v53, v56, v9 row_newbcast:5 row_mask:0xf bank_mask:0xf
    v_and_b32_dpp v54, v56, v10 row_newbcast:5 row_mask:0xf bank_mask:0xf
    v_and_b32_dpp v55, v56, v11 row_newbcast:5 row_mask:0xf bank_mask:0xf
    s_waitcnt vmcnt(4)
    v_mfma_f32_16x16x32_bf16 v[28:31], v[48:51], v[80:83], v[28:31]
    s_add_u32 s58, s56, 0x14000
    buffer_load_dwordx4 v[112:115], v2, s[36:39], s58 offen nt
    v_add_u32 v61, 1, v61
    ds_write_b32 v63, v61
    v_and_b32_dpp v48, v56, v8 row_newbcast:6 row_mask:0xf bank_mask:0xf
    v_and_b32_dpp v49, v56, v9 row_newbcast:6 row_mask:0xf bank_mask:0xf
    v_and_b32_dpp v50, v56, v10 row_newbcast:6 row_mask:0xf bank_mask:0xf
    v_and_b32_dpp v51, v56, v11 row_newbcast:6 row_mask:0xf bank_mask:0xf
    s_waitcnt vmcnt(4)
    v_mfma_f32_16x16x32_bf16 v[28:31], v[52:55], v[84:87], v[28:31]
    s_add_u32 s58, s56, 0x15000
    buffer_load_dwordx4 v[116:119], v2, s[36:39], s58 offen nt
    v_and_b32_dpp v52, v56, v8 row_newbcast:7 row_mask:0xf bank_mask:0xf
    v_and_b32_dpp v53, v56, v9 row_newbcast:7 row_mask:0xf bank_mask:0xf
    v_and_b32_dpp v54, v56, v10 row_newbcast:7 row_mask:0xf bank_mask:0xf
    v_and_b32_dpp v55, v56, v11 row_newbcast:7 row_mask:0xf bank_mask:0xf
    s_waitcnt vmcnt(4)
    v_mfma_f32_16x16x32_bf16 v[28:31], v[48:51], v[88:91], v[28:31]
    s_add_u32 s58, s56, 0x16000
    buffer_load_dwordx4 v[120:123], v2, s[36:39], s58 offen nt
    v_add_u32 v61, 1, v61
    ds_write_b32 v63, v61
    ds_read_b32 v46, v63 offset:16
    v_and_b32_dpp v48, v56, v8 row_newbcast:8 row_mask:0xf bank_mask:0xf
    v_and_b32_dpp v49, v56, v9 row_newbcast:8 row_mask:0xf bank_mask:0xf
    v_and_b32_dpp v50, v56, v10 row_newbcast:8 row_mask:0xf bank_mask:0xf
    v_and_b32_dpp v51, v56, v11 row_newbcast:8 row_mask:0xf bank_mask:0xf
    s_waitcnt vmcnt(4)
    v_mfma_f32_16x16x32_bf16 v[28:31], v[52:55], v[92:95], v[28:31]
    s_add_u32 s58, s56, 0x17000
    buffer_load_dwordx4 v[124:127], v2, s[36:39], s58 offen nt
    v_and_b32_dpp v52, v56, v8 row_newbcast:9 row_mask:0xf bank_mask:0xf
    v_and_b32_dpp v53, v56, v9 row_newbcast:9 row_mask:0xf bank_mask:0xf
    v_and_b32_dpp v54, v56, v10 row_newbcast:9 row_mask:0xf bank_mask:0xf
    v_and_b32_dpp v55, v56, v11 row_newbcast:9 row_mask:0xf bank_mask:0xf
    s_waitcnt vmcnt(4)
    v_mfma_f32_16x16x32_bf16 v[28:31], v[48:51], v[96:99], v[28:31]
    s_add_u32 s58, s57, 0x0
    buffer_load_dwordx4 v[64:67], v3, s[40:43], s58 offen nt
    v_add_u32 v61, 1, v61
    ds_write_b32 v63, v61
    v_and_b32_dpp v48, v56, v8 row_newbcast:10 row_mask:0xf bank_mask:0xf
    v_and_b32_dpp v49, v56, v9 row_newbcast:10 row_mask:0xf bank_mask:0xf
    v_and_b32_dpp v50, v56, v10 row_newbcast:10 row_mask:0xf bank_mask:0xf
    v_and_b32_dpp v51, v56, v11 row_newbcast:10 row_mask:0xf bank_mask:0xf
    s_waitcnt vmcnt(4)
    v_mfma_f32_16x16x32_bf16 v[28:31], v[52:55], v[100:103], v[28:31]
    s_add_u32 s58, s57, 0x1000
    buffer_load_dwordx4 v[68:71], v3, s[40:43], s58 offen nt
    v_and_b32_dpp v52, v56, v8 row_newbcast:11 row_mask:0xf bank_mask:0xf
    v_and_b32_dpp v53, v56, v9 row_newbcast:11 row_mask:0xf bank_mask:0xf
    v_and_b32_dpp v54, v56, v10 row_newbcast:11 row_mask:0xf bank_mask:0xf
    v_and_b32_dpp v55, v56, v11 row_newbcast:11 row_mask:0xf bank_mask:0xf
    s_waitcnt vmcnt(4)
    v_mfma_f32_16x16x32_bf16 v[28:31], v[48:51], v[104:107], v[28:31]
    s_add_u32 s58, s57, 0x2000
    buffer_load_dwordx4 v[72:75], v3, s[40:43], s58 offen nt
    v_add_u32 v61, 1, v61
    ds_write_b32 v63, v61
    v_and_b32_dpp v48, v56, v8 row_newbcast:12 row_mask:0xf bank_mask:0xf
    v_and_b32_dpp v49, v56, v9 row_newbcast:12 row_mask:0xf bank_mask:0xf
    v_and_b32_dpp v50, v56, v10 row_newbcast:12 row_mask:0xf bank_mask:0xf
    v_and_b32_dpp v51, v56, v11 row_newbcast:12 row_mask:0xf bank_mask:0xf
    s_waitcnt vmcnt(4)
    v_mfma_f32_16x16x32_bf16 v[28:31], v[52:55], v[108:111], v[28:31]
    s_add_u32 s58, s57, 0x3000
    buffer_load_dwordx4 v[76:79], v3, s[40:43], s58 offen nt
    v_and_b32_dpp v52, v56, v8 row_newbcast:13 row_mask:0xf bank_mask:0xf
    v_and_b32_dpp v53, v56, v9 row_newbcast:13 row_mask:0xf bank_mask:0xf
    v_and_b32_dpp v54, v56, v10 row_newbcast:13 row_mask:0xf bank_mask:0xf
    v_and_b32_dpp v55, v56, v11 row_newbcast:13 row_mask:0xf bank_mask:0xf
    s_waitcnt vmcnt(4)
    v_mfma_f32_16x16x32_bf16 v[28:31], v[48:51], v[112:115], v[28:31]
    s_add_u32 s58, s57, 0x4000
    buffer_load_dwordx4 v[80:83], v3, s[40:43], s58 offen nt
    v_add_u32 v61, 1, v61
    ds_write_b32 v63, v61
    v_and_b32_dpp v48, v56, v8 row_newbcast:14 row_mask:0xf bank_mask:0xf
    v_and_b32_dpp v49, v56, v9 row_newbcast:14 row_mask:0xf bank_mask:0xf
    v_and_b32_dpp v50, v56, v10 row_newbcast:14 row_mask:0xf bank_mask:0xf
    v_and_b32_dpp v51, v56, v11 row_newbcast:14 row_mask:0xf bank_mask:0xf
    s_waitcnt vmcnt(4)
    v_mfma_f32_16x16x32_bf16 v[28:31], v[52:55], v[116:119], v[28:31]
    s_add_u32 s58, s57, 0x5000
    buffer_load_dwordx4 v[84:87], v3, s[40:43], s58 offen nt
    v_and_b32_dpp v52, v56, v8 row_newbcast:15 row_mask:0xf bank_mask:0xf
    v_and_b32_dpp v53, v56, v9 row_newbcast:15 row_mask:0xf bank_mask:0xf
    v_and_b32_dpp v54, v56, v10 row_newbcast:15 row_mask:0xf bank_mask:0xf
    v_and_b32_dpp v55, v56, v11 row_newbcast:15 row_mask:0xf bank_mask:0xf
    s_waitcnt vmcnt(4)
    v_mfma_f32_16x16x32_bf16 v[28:31], v[48:51], v[120:123], v[28:31]
    s_add_u32 s58, s57, 0x6000
    buffer_load_dwordx4 v[88:91], v3, s[40:43], s58 offen nt
    v_add_u32 v61, 1, v61
    ds_write_b32 v63, v61
    ds_read_b32 v46, v63 offset:16
    s_waitcnt vmcnt(4)
    v_mfma_f32_16x16x32_bf16 v[28:31], v[52:55], v[124:127], v[28:31]
    s_add_u32 s58, s57, 0x7000
    buffer_load_dwordx4 v[92:95], v3, s[40:43], s58 offen nt
    s_mov_b32 s56, s57
    s_mov_b32 s59, 1
L_vloop:
    s_add_u32 s57, s56, 0x20000
    s_cmp_eq_u32 s59, 4
    s_cbranch_scc0 L_vnl
    s_mov_b64 exec, 1
    ds_add_u32 v41, v45
    s_mov_b64 exec, -1
L_vnl:
    s_waitcnt lgkmcnt(0)
    v_readfirstlane_b32 s68, v46
    s_cmp_eq_u32 s68, 1
    s_cbranch_scc1 L_v_b1
    s_cmp_eq_u32 s68, 2
    s_cbranch_scc1 L_v_b2
    s_cmp_eq_u32 s68, 3
    s_cbranch_scc1 L_v_b3
L_v_b0:
    v_mov_b32 v56, v57
    ds_read_b32 v57, v59
    v_add_u32 v59, 256, v59
    v_and_b32_dpp v48, v56, v8 row_newbcast:0 row_mask:0xf bank_mask:0xf
    v_and_b32_dpp v49, v56, v9 row_newbcast:0 row_mask:0xf bank_mask:0xf
    v_and_b32_dpp v50, v56, v10 row_newbcast:0 row_mask:0xf bank_mask:0xf
    v_and_b32_dpp v51, v56, v11 row_newbcast:0 row_mask:0xf bank_mask:0xf
    v_and_b32_dpp v52, v56, v8 row_newbcast:1 row_mask:0xf bank_mask:0xf
    v_and_b32_dpp v53, v56, v9 row_newbcast:1 row_mask:0xf bank_mask:0xf
    v_and_b32_dpp v54, v56, v10 row_newbcast:1 row_mask:0xf bank_mask:0xf
    v_and_b32_dpp v55, v56, v11 row_newbcast:1 row_mask:0xf bank_mask:0xf
    s_waitcnt vmcnt(3)
    s_add_u32 s58, s56, 0x10000
    buffer_load_dwordx4 v[96:99], v2, s[36:39], s58 offen nt
    v_add_u32 v61, 1, v61
    ds_write_b32 v63, v61
    v_mfma_f32_16x16x32_bf16 v[28:31], v[48:51], v[64:67], v[28:31]
    v_and_b32_dpp v48, v56, v8 row_newbcast:2 row_mask:0xf bank_mask:0xf
    v_and_b32_dpp v49, v56, v9 row_newbcast:2 row_mask:0xf bank_mask:0xf
    v_and_b32_dpp v50, v56, v10 row_newbcast:2 row_mask:0xf bank_mask:0xf
    v_and_b32_dpp v51, v56, v11 row_newbcast:2 row_mask:0xf bank_mask:0xf
    s_waitcnt vmcnt(3)
    s_add_u32 s58, s56, 0x11000
    buffer_load_dwordx4 v[100:103], v2, s[36:39], s58 offen nt
    v_mfma_f32_16x16x32_bf16 v[28:31], v[52:55], v[68:71], v[28:31]
    v_and_b32_dpp v52, v56, v8 row_newbcast:3 row_mask:0xf bank_mask:0xf
    v_and_b32_dpp v53, v56, v9 row_newbcast:3 row_mask:0xf bank_mask:0xf
    v_and_b32_dpp v54, v56, v10 row_newbcast:3 row_mask:0xf bank_mask:0xf
    v_and_b32_dpp v55, v56, v11 row_newbcast:3 row_mask:0xf bank_mask:0xf
    s_waitcnt vmcnt(3)
    s_add_u32 s58, s56, 0x12000
    buffer_load_dwordx4 v[104:107], v2, s[36:39], s58 offen nt
    v_add_u32 v61, 1, v61
    ds_write_b32 v63, v61
    v_mfma_f32_16x16x32_bf16 v[28:31], v[48:51], v[72:75], v[28:31]
    v_and_b32_dpp v48, v56, v8 row_newbcast:4 row_mask:0xf bank_mask:0xf
    v_and_b32_dpp v49, v56, v9 row_newbcast:4 row_mask:0xf bank_mask:0xf
    v_and_b32_dpp v50, v56, v10 row_newbcast:4 row_mask:0xf bank_mask:0xf
    v_and_b32_dpp v51, v56, v11 row_newbcast:4 row_mask:0xf bank_mask:0xf
    s_waitcnt vmcnt(3)
    s_add_u32 s58, s56, 0x13000
    buffer_load_dwordx4 v[108:111], v2, s[36:39], s58 offen nt
    v_mfma_f32_16x16x32_bf16 v[28:31], v[52:55], v[76:79], v[28:31]
    v_and_b32_dpp v52, v56, v8 row_newbcast:5 row_mask:0xf bank_mask:0xf
    v_and_b32_dpp v53, v56, v9 row_newbcast:5 row_mask:0xf bank_mask:0xf
    v_and_b32_dpp v54, v56, v10 row_newbcast:5 row_mask:0xf bank_mask:0xf
    v_and_b32_dpp v55, v56, v11 row_newbcast:5 row_mask:0xf bank_mask:0xf
    s_waitcnt vmcnt(3)
    s_add_u32 s58, s56, 0x14000
    buffer_load_dwordx4 v[112:115], v2, s[36:39], s58 offen nt
    v_add_u32 v61, 1, v61
    ds_write_b32 v63, v61
    v_mfma_f32_16x16x32_bf16 v[28:31], v[48:51], v[80:83], v[28:31]
    v_and_b32_dpp v48, v56, v8 row_newbcast:6 row_mask:0xf bank_mask:0xf
    v_and_b32_dpp v49, v56, v9 row_newbcast:6 row_mask:0xf bank_mask:0xf
    v_and_b32_dpp v50, v56, v10 row_newbcast:6 row_mask:0xf bank_mask:0xf
    v_and_b32_dpp v51, v56, v11 row_newbcast:6 row_mask:0xf bank_mask:0xf
    s_waitcnt vmcnt(3)
    s_add_u32 s58, s56, 0x15000
    buffer_load_dwordx4 v[116:119], v2, s[36:39], s58 offen nt
    v_mfma_f32_16x16x32_bf16 v[28:31], v[52:55], v[84:87], v[28:31]
    v_and_b32_dpp v52, v56, v8 row_newbcast:7 row_mask:0xf bank_mask:0xf
    v_and_b32_dpp v53, v56, v9 row_newbcast:7 row_mask:0xf bank_mask:0xf
    v_and_b32_dpp v54, v56, v10 row_newbcast:7 row_mask:0xf bank_mask:0xf
    v_and_b32_dpp v55, v56, v11 row_newbcast:7 row_mask:0xf bank_mask:0xf
    s_waitcnt vmcnt(3)
    s_add_u32 s58, s56, 0x16000
    buffer_load_dwordx4 v[120:123], v2, s[36:39], s58 offen nt
    v_add_u32 v61, 1, v61
    ds_write_b32 v63, v61
    ds_read_b32 v46, v63 offset:16
    v_mfma_f32_16x16x32_bf16 v[28:31], v[48:51], v[88:91], v[28:31]
    v_and_b32_dpp v48, v56, v8 row_newbcast:8 row_mask:0xf bank_mask:0xf
    v_and_b32_dpp v49, v56, v9 row_newbcast:8 row_mask:0xf bank_mask:0xf
    v_and_b32_dpp v50, v56, v10 row_newbcast:8 row_mask:0xf bank_mask:0xf
    v_and_b32_dpp v51, v56, v11 row_newbcast:8 row_mask:0xf bank_mask:0xf
    s_waitcnt vmcnt(3)
    s_add_u32 s58, s56, 0x17000
    buffer_load_dwordx4 v[124:127], v2, s[36:39], s58 offen nt
    v_mfma_f32_16x16x32_bf16 v[28:31], v[52:55], v[92:95], v[28:31]
    s_waitcnt lgkmcnt(0)
    v_readfirstlane_b32 s68, v46
    s_cmp_eq_u32 s68, 1
    s_cbranch_scc1 L_v_h1
    s_cmp_eq_u32 s68, 2
    s_cbranch_scc1 L_v_h2
    s_cmp_eq_u32 s68, 3
    s_cbranch_scc1 L_v_h3
L_v_h0:
    v_and_b32_dpp v52, v56, v8 row_newbcast:9 row_mask:0xf bank_mask:0xf
    v_and_b32_dpp v53, v56, v9 row_newbcast:9 row_mask:0xf bank_mask:0xf
    v_and_b32_dpp v54, v56, v10 row_newbcast:9 row_mask:0xf bank_mask:0xf
    v_and_b32_dpp v55, v56, v11 row_newbcast:9 row_mask:0xf bank_mask:0xf
    s_waitcnt vmcnt(3)
    s_add_u32 s58, s57, 0x0
    buffer_load_dwordx4 v[64:67], v3, s[40:43], s58 offen nt
    v_add_u32 v61, 1, v61
    ds_write_b32 v63, v61
    v_mfma_f32_16x16x32_bf16 v[28:31], v[48:51], v[96:99], v[28:31]
    v_and_b32_dpp v48, v56, v8 row_newbcast:10 row_mask:0xf bank_mask:0xf
    v_and_b32_dpp v49, v56, v9 row_newbcast:10 row_mask:0xf bank_mask:0xf
    v_and_b32_dpp v50, v56, v10 row_newbcast:10 row_mask:0xf bank_mask:0xf
    v_and_b32_dpp v51, v56, v11 row_newbcast:10 row_mask:0xf bank_mask:0xf
    s_waitcnt vmcnt(3)
    s_add_u32 s58, s57, 0x1000
    buffer_load_dwordx4 v[68:71], v3, s[40:43], s58 offen nt
    v_mfma_f32_16x16x32_bf16 v[28:31], v[52:55], v[100:103], v[28:31]
    v_and_b32_dpp v52, v56, v8 row_newbcast:11 row_mask:0xf bank_mask:0xf
    v_and_b32_dpp v53, v56, v9 row_newbcast:11 row_mask:0xf bank_mask:0xf
    v_and_b32_dpp v54, v56, v10 row_newbcast:11 row_mask:0xf bank_mask:0xf
    v_and_b32_dpp v55, v56, v11 row_newbcast:11 row_mask:0xf bank_mask:0xf
    s_waitcnt vmcnt(3)
    s_add_u32 s58, s57, 0x2000
    buffer_load_dwordx4 v[72:75], v3, s[40:43], s58 offen nt
    v_add_u32 v61, 1, v61
    ds_write_b32 v63, v61
    v_mfma_f32_16x16x32_bf16 v[28:31], v[48:51], v[104:107], v[28:31]
    v_and_b32_dpp v48, v56, v8 row_newbcast:12 row_mask:0xf bank_mask:0xf
    v_and_b32_dpp v49, v56, v9 row_newbcast:12 row_mask:0xf bank_mask:0xf
    v_and_b32_dpp v50, v56, v10 row_newbcast:12 row_mask:0xf bank_mask:0xf
    v_and_b32_dpp v51, v56, v11 row_newbcast:12 row_mask:0xf bank_mask:0xf
    s_waitcnt vmcnt(3)
    s_add_u32 s58, s57, 0x3000
    buffer_load_dwordx4 v[76:79], v3, s[40:43], s58 offen nt
    v_mfma_f32_16x16x32_bf16 v[28:31], v[52:55], v[108:111], v[28:31]
    v_and_b32_dpp v52, v56, v8 row_newbcast:13 row_mask:0xf bank_mask:0xf
    v_and_b32_dpp v53, v56, v9 row_newbcast:13 row_mask:0xf bank_mask:0xf
    v_and_b32_dpp v54, v56, v10 row_newbcast:13 row_mask:0xf bank_mask:0xf
    v_and_b32_dpp v55, v56, v11 row_newbcast:13 row_mask:0xf bank_mask:0xf
    s_waitcnt vmcnt(3)
    s_add_u32 s58, s57, 0x4000
    buffer_load_dwordx4 v[80:83], v3, s[40:43], s58 offen nt
    v_add_u32 v61, 1, v61
    ds_write_b32 v63, v61
    v_mfma_f32_16x16x32_bf16 v[28:31], v[48:51], v[112:115], v[28:31]
    v_and_b32_dpp v48, v56, v8 row_newbcast:14 row_mask:0xf bank_mask:0xf
    v_and_b32_dpp v49, v56, v9 row_newbcast:14 row_mask:0xf bank_mask:0xf
    v_and_b32_dpp v50, v56, v10 row_newbcast:14 row_mask:0xf bank_mask:0xf
    v_and_b32_dpp v51, v56, v11 row_newbcast:14 row_mask:0xf bank_mask:0xf
    s_waitcnt vmcnt(3)
    s_add_u32 s58, s57, 0x5000
    buffer_load_dwordx4 v[84:87], v3, s[40:43], s58 offen nt
    v_mfma_f32_16x16x32_bf16 v[28:31], v[52:55], v[116:119], v[28:31]
    v_and_b32_dpp v52, v56, v8 row_newbcast:15 row_mask:0xf bank_mask:0xf
    v_and_b32_dpp v53, v56, v9 row_newbcast:15 row_mask:0xf bank_mask:0xf
    v_and_b32_dpp v54, v56, v10 row_newbcast:15 row_mask:0xf bank_mask:0xf
    v_and_b32_dpp v55, v56, v11 row_newbcast:15 row_mask:0xf bank_mask:0xf
    s_waitcnt vmcnt(3)
    s_add_u32 s58, s57, 0x6000
    buffer_load_dwordx4 v[88:91], v3, s[40:43], s58 offen nt
    v_add_u32 v61, 1, v61
    ds_write_b32 v63, v61
    ds_read_b32 v46, v63 offset:16
    v_mfma_f32_16x16x32_bf16 v[28:31], v[48:51], v[120:123], v[28:31]
    s_waitcnt vmcnt(3)
    s_add_u32 s58, s57, 0x7000
    buffer_load_dwordx4 v[92:95], v3, s[40:43], s58 offen nt
    v_mfma_f32_16x16x32_bf16 v[28:31], v[52:55], v[124:127], v[28:31]
    s_branch L_v_e
L_v_b1:
    v_mov_b32 v56, v57
    ds_read_b32 v57, v59
    v_add_u32 v59, 256, v59
    v_and_b32_dpp v48, v56, v8 row_newbcast:0 row_mask:0xf bank_mask:0xf
    v_and_b32_dpp v49, v56, v9 row_newbcast:0 row_mask:0xf bank_mask:0xf
    v_and_b32_dpp v50, v56, v10 row_newbcast:0 row_mask:0xf bank_mask:0xf
    v_and_b32_dpp v51, v56, v11 row_newbcast:0 row_mask:0xf bank_mask:0xf
    v_and_b32_dpp v52, v56, v8 row_newbcast:1 row_mask:0xf bank_mask:0xf
    v_and_b32_dpp v53, v56, v9 row_newbcast:1 row_mask:0xf bank_mask:0xf
    v_and_b32_dpp v54, v56, v10 row_newbcast:1 row_mask:0xf bank_mask:0xf
    v_and_b32_dpp v55, v56, v11 row_newbcast:1 row_mask:0xf bank_mask:0xf
    s_waitcnt vmcnt(4)
    s_add_u32 s58, s56, 0x10000
    buffer_load_dwordx4 v[96:99], v2, s[36:39], s58 offen nt
    v_add_u32 v61, 1, v61
    ds_write_b32 v63, v61
    v_mfma_f32_16x16x32_bf16 v[28:31], v[48:51], v[64:67], v[28:31]
    v_and_b32_dpp v48, v56, v8 row_newbcast:2 row_mask:0xf bank_mask:0xf
    v_and_b32_dpp v49, v56, v9 row_newbcast:2 row_mask:0xf bank_mask:0xf
    v_and_b32_dpp v50, v56, v10 row_newbcast:2 row_mask:0xf bank_mask:0xf
    v_and_b32_dpp v51, v56, v11 row_newbcast:2 row_mask:0xf bank_mask:0xf
    s_waitcnt vmcnt(4)
    s_add_u32 s58, s56, 0x11000
    buffer_load_dwordx4 v[100:103], v2, s[36:39], s58 offen nt
    v_mfma_f32_16x16x32_bf16 v[28:31], v[52:55], v[68:71], v[28:31]
    v_and_b32_dpp v52, v56, v8 row_newbcast:3 row_mask:0xf bank_mask:0xf
    v_and_b32_dpp v53, v56, v9 row_newbcast:3 row_mask:0xf bank_mask:0xf
    v_and_b32_dpp v54, v56, v10 row_newbcast:3 row_mask:0xf bank_mask:0xf
    v_and_b32_dpp v55, v56, v11 row_newbcast:3 row_mask:0xf bank_mask:0xf
    s_waitcnt vmcnt(4)
    s_add_u32 s58, s56, 0x12000
    buffer_load_dwordx4 v[104:107], v2, s[36:39], s58 offen nt
    v_add_u32 v61, 1, v61
    ds_write_b32 v63, v61
    v_mfma_f32_16x16x32_bf16 v[28:31], v[48:51], v[72:75], v[28:31]
    v_and_b32_dpp v48, v56, v8 row_newbcast:4 row_mask:0xf bank_mask:0xf
    v_and_b32_dpp v49, v56, v9 row_newbcast:4 row_mask:0xf bank_mask:0xf
    v_and_b32_dpp v50, v56, v10 row_newbcast:4 row_mask:0xf bank_mask:0xf
    v_and_b32_dpp v51, v56, v11 row_newbcast:4 row_mask:0xf bank_mask:0xf
    s_waitcnt vmcnt(4)
    s_add_u32 s58, s56, 0x13000
    buffer_load_dwordx4 v[108:111], v2, s[36:39], s58 offen nt
    v_mfma_f32_16x16x32_bf16 v[28:31], v[52:55], v[76:79], v[28:31]
    v_and_b32_dpp v52, v56, v8 row_newbcast:5 row_mask:0xf bank_mask:0xf
    v_and_b32_dpp v53, v56, v9 row_newbcast:5 row_mask:0xf bank_mask:0xf
    v_and_b32_dpp v54, v56, v10 row_newbcast:5 row_mask:0xf bank_mask:0xf
    v_and_b32_dpp v55, v56, v11 row_newbcast:5 row_mask:0xf bank_mask:0xf
    s_waitcnt vmcnt(4)
    s_add_u32 s58, s56, 0x14000
    buffer_load_dwordx4 v[112:115], v2, s[36:39], s58 offen nt
    v_add_u32 v61, 1, v61
    ds_write_b32 v63, v61
    v_mfma_f32_16x16x32_bf16 v[28:31], v[48:51], v[80:83], v[28:31]
    v_and_b32_dpp v48, v56, v8 row_newbcast:6 row_mask:0xf bank_mask:0xf
    v_and_b32_dpp v49, v56, v9 row_newbcast:6 row_mask:0xf bank_mask:0xf
    v_and_b32_dpp v50, v56, v10 row_newbcast:6 row_mask:0xf bank_mask:0xf
    v_and_b32_dpp v51, v56, v11 row_newbcast:6 row_mask:0xf bank_mask:0xf
    s_waitcnt vmcnt(4)
    s_add_u32 s58, s56, 0x15000
    buffer_load_dwordx4 v[116:119], v2, s[36:39], s58 offen nt
    v_mfma_f32_16x16x32_bf16 v[28:31], v[52:55], v[84:87], v[28:31]
    v_and_b32_dpp v52, v56, v8 row_newbcast:7 row_mask:0xf bank_mask:0xf
    v_and_b32_dpp v53, v56, v9 row_newbcast:7 row_mask:0xf bank_mask:0xf
    v_and_b32_dpp v54, v56, v10 row_newbcast:7 row_mask:0xf bank_mask:0xf
    v_and_b32_dpp v55, v56, v11 row_newbcast:7 row_mask:0xf bank_mask:0xf
    s_waitcnt vmcnt(4)
    s_add_u32 s58, s56, 0x16000
    buffer_load_dwordx4 v[120:123], v2, s[36:39], s58 offen nt
    v_add_u32 v61, 1, v61
    ds_write_b32 v63, v61
    ds_read_b32 v46, v63 offset:16
    v_mfma_f32_16x16x32_bf16 v[28:31], v[48:51], v[88:91], v[28:31]
    v_and_b32_dpp v48, v56, v8 row_newbcast:8 row_mask:0xf bank_mask:0xf
    v_and_b32_dpp v49, v56, v9 row_newbcast:8 row_mask:0xf bank_mask:0xf
    v_and_b32_dpp v50, v56, v10 row_newbcast:8 row_mask:0xf bank_mask:0xf
    v_and_b32_dpp v51, v56, v11 row_newbcast:8 row_mask:0xf bank_mask:0xf
    s_waitcnt vmcnt(4)
    s_add_u32 s58, s56, 0x17000
    buffer_load_dwordx4 v[124:127], v2, s[36:39], s58 offen nt
    v_mfma_f32_16x16x32_bf16 v[28:31], v[52:55], v[92:95], v[28:31]
    s_waitcnt lgkmcnt(0)
    v_readfirstlane_b32 s68, v46
    s_cmp_eq_u32 s68, 0
    s_cbranch_scc1 L_v_h0
    s_cmp_eq_u32 s68, 2
    s_cbranch_scc1 L_v_h2
    s_cmp_eq_u32 s68, 3
    s_cbranch_scc1 L_v_h3
L_v_h1:
    v_and_b32_dpp v52, v56, v8 row_newbcast:9 row_mask:0xf bank_mask:0xf
    v_and_b32_dpp v53, v56, v9 row_newbcast:9 row_mask:0xf bank_mask:0xf
    v_and_b32_dpp v54, v56, v10 row_newbcast:9 row_mask:0xf bank_mask:0xf
    v_and_b32_dpp v55, v56, v11 row_newbcast:9 row_mask:0xf bank_mask:0xf
    s_waitcnt vmcnt(4)
    s_add_u32 s58, s57, 0x0
    buffer_load_dwordx4 v[64:67], v3, s[40:43], s58 offen nt
    v_add_u32 v61, 1, v61
    ds_write_b32 v63, v61
    v_mfma_f32_16x16x32_bf16 v[28:31], v[48:51], v[96:99], v[28:31]
    v_and_b32_dpp v48, v56, v8 row_newbcast:10 row_mask:0xf bank_mask:0xf
    v_and_b32_dpp v49, v56, v9 row_newbcast:10 row_mask:0xf bank_mask:0xf
    v_and_b32_dpp v50, v56, v10 row_newbcast:10 row_mask:0xf bank_mask:0xf
    v_and_b32_dpp v51, v56, v11 row_newbcast:10 row_mask:0xf bank_mask:0xf
    s_waitcnt vmcnt(4)
    s_add_u32 s58, s57, 0x1000
    buffer_load_dwordx4 v[68:71], v3, s[40:43], s58 offen nt
    v_mfma_f32_16x16x32_bf16 v[28:31], v[52:55], v[100:103], v[28:31]
    v_and_b32_dpp v52, v56, v8 row_newbcast:11 row_mask:0xf bank_mask:0xf
    v_and_b32_dpp v53, v56, v9 row_newbcast:11 row_mask:0xf bank_mask:0xf
    v_and_b32_dpp v54, v56, v10 row_newbcast:11 row_mask:0xf bank_mask:0xf
    v_and_b32_dpp v55, v56, v11 row_newbcast:11 row_mask:0xf bank_mask:0xf
    s_waitcnt vmcnt(4)
    s_add_u32 s58, s57, 0x2000
    buffer_load_dwordx4 v[72:75], v3, s[40:43], s58 offen nt
    v_add_u32 v61, 1, v61
    ds_write_b32 v63, v61
    v_mfma_f32_16x16x32_bf16 v[28:31], v[48:51], v[104:107], v[28:31]
    v_and_b32_dpp v48, v56, v8 row_newbcast:12 row_mask:0xf bank_mask:0xf
    v_and_b32_dpp v49, v56, v9 row_newbcast:12 row_mask:0xf bank_mask:0xf
    v_and_b32_dpp v50, v56, v10 row_newbcast:12 row_mask:0xf bank_mask:0xf
    v_and_b32_dpp v51, v56, v11 row_newbcast:12 row_mask:0xf bank_mask:0xf
    s_waitcnt vmcnt(4)
    s_add_u32 s58, s57, 0x3000
    buffer_load_dwordx4 v[76:79], v3, s[40:43], s58 offen nt
    v_mfma_f32_16x16x32_bf16 v[28:31], v[52:55], v[108:111], v[28:31]
    v_and_b32_dpp v52, v56, v8 row_newbcast:13 row_mask:0xf bank_mask:0xf
    v_and_b32_dpp v53, v56, v9 row_newbcast:13 row_mask:0xf bank_mask:0xf
    v_and_b32_dpp v54, v56, v10 row_newbcast:13 row_mask:0xf bank_mask:0xf
    v_and_b32_dpp v55, v56, v11 row_newbcast:13 row_mask:0xf bank_mask:0xf
    s_waitcnt vmcnt(4)
    s_add_u32 s58, s57, 0x4000
    buffer_load_dwordx4 v[80:83], v3, s[40:43], s58 offen nt
    v_add_u32 v61, 1, v61
    ds_write_b32 v63, v61
    v_mfma_f32_16x16x32_bf16 v[28:31], v[48:51], v[112:115], v[28:31]
    v_and_b32_dpp v48, v56, v8 row_newbcast:14 row_mask:0xf bank_mask:0xf
    v_and_b32_dpp v49, v56, v9 row_newbcast:14 row_mask:0xf bank_mask:0xf
    v_and_b32_dpp v50, v56, v10 row_newbcast:14 row_mask:0xf bank_mask:0xf
    v_and_b32_dpp v51, v56, v11 row_newbcast:14 row_mask:0xf bank_mask:0xf
    s_waitcnt vmcnt(4)
    s_add_u32 s58, s57, 0x5000
    buffer_load_dwordx4 v[84:87], v3, s[40:43], s58 offen nt
    v_mfma_f32_16x16x32_bf16 v[28:31], v[52:55], v[116:119], v[28:31]
    v_and_b32_dpp v52, v56, v8 row_newbcast:15 row_mask:0xf bank_mask:0xf
    v_and_b32_dpp v53, v56, v9 row_newbcast:15 row_mask:0xf bank_mask:0xf
    v_and_b32_dpp v54, v56, v10 row_newbcast:15 row_mask:0xf bank_mask:0xf
    v_and_b32_dpp v55, v56, v11 row_newbcast:15 row_mask:0xf bank_mask:0xf
    s_waitcnt vmcnt(4)
    s_add_u32 s58, s57, 0x6000
    buffer_load_dwordx4 v[88:91], v3, s[40:43], s58 offen nt
    v_add_u32 v61, 1, v61
    ds_write_b32 v63, v61
    ds_read_b32 v46, v63 offset:16
    v_mfma_f32_16x16x32_bf16 v[28:31], v[48:51], v[120:123], v[28:31]
    s_waitcnt vmcnt(4)
    s_add_u32 s58, s57, 0x7000
    buffer_load_dwordx4 v[92:95], v3, s[40:43], s58 offen nt
    v_mfma_f32_16x16x32_bf16 v[28:31], v[52:55], v[124:127], v[28:31]
    s_branch L_v_e
L_v_b2:
    v_mov_b32 v56, v57
    ds_read_b32 v57, v59
    v_add_u32 v59, 256, v59
    v_and_b32_dpp v48, v56, v8 row_newbcast:0 row_mask:0xf bank_mask:0xf
    v_and_b32_dpp v49, v56, v9 row_newbcast:0 row_mask:0xf bank_mask:0xf
    v_and_b32_dpp v50, v56, v10 row_newbcast:0 row_mask:0xf bank_mask:0xf
    v_and_b32_dpp v51, v56, v11 row_newbcast:0 row_mask:0xf bank_mask:0xf
    v_and_b32_dpp v52, v56, v8 row_newbcast:1 row_mask:0xf bank_mask:0xf
    v_and_b32_dpp v53, v56, v9 row_newbcast:1 row_mask:0xf bank_mask:0xf
    v_and_b32_dpp v54, v56, v10 row_newbcast:1 row_mask:0xf bank_mask:0xf
    v_and_b32_dpp v55, v56, v11 row_newbcast:1 row_mask:0xf bank_mask:0xf
    s_waitcnt vmcnt(5)
    s_add_u32 s58, s56, 0x10000
    buffer_load_dwordx4 v[96:99], v2, s[36:39], s58 offen nt
    v_add_u32 v61, 1, v61
    ds_write_b32 v63, v61
    v_mfma_f32_16x16x32_bf16 v[28:31], v[48:51], v[64:67], v[28:31]
    v_and_b32_dpp v48, v56, v8 row_newbcast:2 row_mask:0xf bank_mask:0xf
    v_and_b32_dpp v49, v56, v9 row_newbcast:2 row_mask:0xf bank_mask:0xf
    v_and_b32_dpp v50, v56, v10 row_newbcast:2 row_mask:0xf bank_mask:0xf
    v_and_b32_dpp v51, v56, v11 row_newbcast:2 row_mask:0xf bank_mask:0xf
    s_waitcnt vmcnt(5)
    s_add_u32 s58, s56, 0x11000
    buffer_load_dwordx4 v[100:103], v2, s[36:39], s58 offen nt
    v_mfma_f32_16x16x32_bf16 v[28:31], v[52:55], v[68:71], v[28:31]
    v_and_b32_dpp v52, v56, v8 row_newbcast:3 row_mask:0xf bank_mask:0xf
    v_and_b32_dpp v53, v56, v9 row_newbcast:3 row_mask:0xf bank_mask:0xf
    v_and_b32_dpp v54, v56, v10 row_newbcast:3 row_mask:0xf bank_mask:0xf
    v_and_b32_dpp v55, v56, v11 row_newbcast:3 row_mask:0xf bank_mask:0xf
    s_waitcnt vmcnt(5)
    s_add_u32 s58, s56, 0x12000
    buffer_load_dwordx4 v[104:107], v2, s[36:39], s58 offen nt
    v_add_u32 v61, 1, v61
    ds_write_b32 v63, v61
    v_mfma_f32_16x16x32_bf16 v[28:31], v[48:51], v[72:75], v[28:31]
    v_and_b32_dpp v48, v56, v8 row_newbcast:4 row_mask:0xf bank_mask:0xf
    v_and_b32_dpp v49, v56, v9 row_newbcast:4 row_mask:0xf bank_mask:0xf
    v_and_b32_dpp v50, v56, v10 row_newbcast:4 row_mask:0xf bank_mask:0xf
    v_and_b32_dpp v51, v56, v11 row_newbcast:4 row_mask:0xf bank_mask:0xf
    s_waitcnt vmcnt(5)
    s_add_u32 s58, s56, 0x13000
    buffer_load_dwordx4 v[108:111], v2, s[36:39], s58 offen nt
    v_mfma_f32_16x16x32_bf16 v[28:31], v[52:55], v[76:79], v[28:31]
    v_and_b32_dpp v52, v56, v8 row_newbcast:5 row_mask:0xf bank_mask:0xf
    v_and_b32_dpp v53, v56, v9 row_newbcast:5 row_mask:0xf bank_mask:0xf
    v_and_b32_dpp v54, v56, v10 row_newbcast:5 row_mask:0xf bank_mask:0xf
    v_and_b32_dpp v55, v56, v11 row_newbcast:5 row_mask:0xf bank_mask:0xf
    s_waitcnt vmcnt(5)
    s_add_u32 s58, s56, 0x14000
    buffer_load_dwordx4 v[112:115], v2, s[36:39], s58 offen nt
    v_add_u32 v61, 1, v61
    ds_write_b32 v63, v61
    v_mfma_f32_16x16x32_bf16 v[28:31], v[48:51], v[80:83], v[28:31]
    v_and_b32_dpp v48, v56, v8 row_newbcast:6 row_mask:0xf bank_mask:0xf
    v_and_b32_dpp v49, v56, v9 row_newbcast:6 row_mask:0xf bank_mask:0xf
    v_and_b32_dpp v50, v56, v10 row_newbcast:6 row_mask:0xf bank_mask:0xf
    v_and_b32_dpp v51, v56, v11 row_newbcast:6 row_mask:0xf bank_mask:0xf
    s_waitcnt vmcnt(5)
    s_add_u32 s58, s56, 0x15000
    buffer_load_dwordx4 v[116:119], v2, s[36:39], s58 offen nt
    v_mfma_f32_16x16x32_bf16 v[28:31], v[52:55], v[84:87], v[28:31]
    v_and_b32_dpp v52, v56, v8 row_newbcast:7 row_mask:0xf bank_mask:0xf
    v_and_b32_dpp v53, v56, v9 row_newbcast:7 row_mask:0xf bank_mask:0xf
    v_and_b32_dpp v54, v56, v10 row_newbcast:7 row_mask:0xf bank_mask:0xf
    v_and_b32_dpp v55, v56, v11 row_newbcast:7 row_mask:0xf bank_mask:0xf
    s_waitcnt vmcnt(5)
    s_add_u32 s58, s56, 0x16000
    buffer_load_dwordx4 v[120:123], v2, s[36:39], s58 offen nt
    v_add_u32 v61, 1, v61
    ds_write_b32 v63, v61
    ds_read_b32 v46, v63 offset:16
    v_mfma_f32_16x16x32_bf16 v[28:31], v[48:51], v[88:91], v[28:31]
    v_and_b32_dpp v48, v56, v8 row_newbcast:8 row_mask:0xf bank_mask:0xf
    v_and_b32_dpp v49, v56, v9 row_newbcast:8 row_mask:0xf bank_mask:0xf
    v_and_b32_dpp v50, v56, v10 row_newbcast:8 row_mask:0xf bank_mask:0xf
    v_and_b32_dpp v51, v56, v11 row_newbcast:8 row_mask:0xf bank_mask:0xf
    s_waitcnt vmcnt(5)
    s_add_u32 s58, s56, 0x17000
    buffer_load_dwordx4 v[124:127], v2, s[36:39], s58 offen nt
    v_mfma_f32_16x16x32_bf16 v[28:31], v[52:55], v[92:95], v[28:31]
    s_waitcnt lgkmcnt(0)
    v_readfirstlane_b32 s68, v46
    s_cmp_eq_u32 s68, 0
    s_cbranch_scc1 L_v_h0
    s_cmp_eq_u32 s68, 1
    s_cbranch_scc1 L_v_h1
    s_cmp_eq_u32 s68, 3
    s_cbranch_scc1 L_v_h3
L_v_h2:
    v_and_b32_dpp v52, v56, v8 row_newbcast:9 row_mask:0xf bank_mask:0xf
    v_and_b32_dpp v53, v56, v9 row_newbcast:9 row_mask:0xf bank_mask:0xf
    v_and_b32_dpp v54, v56, v10 row_newbcast:9 row_mask:0xf bank_mask:0xf
    v_and_b32_dpp v55, v56, v11 row_newbcast:9 row_mask:0xf bank_mask:0xf
    s_waitcnt vmcnt(5)
    s_add_u32 s58, s57, 0x0
    buffer_load_dwordx4 v[64:67], v3, s[40:43], s58 offen nt
    v_add_u32 v61, 1, v61
    ds_write_b32 v63, v61
    v_mfma_f32_16x16x32_bf16 v[28:31], v[48:51], v[96:99], v[28:31]
    v_and_b32_dpp v48, v56, v8 row_newbcast:10 row_mask:0xf bank_mask:0xf
    v_and_b32_dpp v49, v56, v9 row_newbcast:10 row_mask:0xf bank_mask:0xf
    v_and_b32_dpp v50, v56, v10 row_newbcast:10 row_mask:0xf bank_mask:0xf
    v_and_b32_dpp v51, v56, v11 row_newbcast:10 row_mask:0xf bank_mask:0xf
    s_waitcnt vmcnt(5)
    s_add_u32 s58, s57, 0x1000
    buffer_load_dwordx4 v[68:71], v3, s[40:43], s58 offen nt
    v_mfma_f32_16x16x32_bf16 v[28:31], v[52:55], v[100:103], v[28:31]
    v_and_b32_dpp v52, v56, v8 row_newbcast:11 row_mask:0xf bank_mask:0xf
    v_and_b32_dpp v53, v56, v9 row_newbcast:11 row_mask:0xf bank_mask:0xf
    v_and_b32_dpp v54, v56, v10 row_newbcast:11 row_mask:0xf bank_mask:0xf
    v_and_b32_dpp v55, v56, v11 row_newbcast:11 row_mask:0xf bank_mask:0xf
    s_waitcnt vmcnt(5)
    s_add_u32 s58, s57, 0x2000
    buffer_load_dwordx4 v[72:75], v3, s[40:43], s58 offen nt
    v_add_u32 v61, 1, v61
    ds_write_b32 v63, v61
    v_mfma_f32_16x16x32_bf16 v[28:31], v[48:51], v[104:107], v[28:31]
    v_and_b32_dpp v48, v56, v8 row_newbcast:12 row_mask:0xf bank_mask:0xf
    v_and_b32_dpp v49, v56, v9 row_newbcast:12 row_mask:0xf bank_mask:0xf
    v_and_b32_dpp v50, v56, v10 row_newbcast:12 row_mask:0xf bank_mask:0xf
    v_and_b32_dpp v51, v56, v11 row_newbcast:12 row_mask:0xf bank_mask:0xf
    s_waitcnt vmcnt(5)
    s_add_u32 s58, s57, 0x3000
    buffer_load_dwordx4 v[76:79], v3, s[40:43], s58 offen nt
    v_mfma_f32_16x16x32_bf16 v[28:31], v[52:55], v[108:111], v[28:31]
    v_and_b32_dpp v52, v56, v8 row_newbcast:13 row_mask:0xf bank_mask:0xf
    v_and_b32_dpp v53, v56, v9 row_newbcast:13 row_mask:0xf bank_mask:0xf
    v_and_b32_dpp v54, v56, v10 row_newbcast:13 row_mask:0xf bank_mask:0xf
    v_and_b32_dpp v55, v56, v11 row_newbcast:13 row_mask:0xf bank_mask:0xf
    s_waitcnt vmcnt(5)
    s_add_u32 s58, s57, 0x4000
    buffer_load_dwordx4 v[80:83], v3, s[40:43], s58 offen nt
    v_add_u32 v61, 1, v61
    ds_write_b32 v63, v61
    v_mfma_f32_16x16x32_bf16 v[28:31], v[48:51], v[112:115], v[28:31]
    v_and_b32_dpp v48, v56, v8 row_newbcast:14 row_mask:0xf bank_mask:0xf
    v_and_b32_dpp v49, v56, v9 row_newbcast:14 row_mask:0xf bank_mask:0xf
    v_and_b32_dpp v50, v56, v10 row_newbcast:14 row_mask:0xf bank_mask:0xf
    v_and_b32_dpp v51, v56, v11 row_newbcast:14 row_mask:0xf bank_mask:0xf
    s_waitcnt vmcnt(5)
    s_add_u32 s58, s57, 0x5000
    buffer_load_dwordx4 v[84:87], v3, s[40:43], s58 offen nt
    v_mfma_f32_16x16x32_bf16 v[28:31], v[52:55], v[116:119], v[28:31]
    v_and_b32_dpp v52, v56, v8 row_newbcast:15 row_mask:0xf bank_mask:0xf
    v_and_b32_dpp v53, v56, v9 row_newbcast:15 row_mask:0xf bank_mask:0xf
    v_and_b32_dpp v54, v56, v10 row_newbcast:15 row_mask:0xf bank_mask:0xf
    v_and_b32_dpp v55, v56, v11 row_newbcast:15 row_mask:0xf bank_mask:0xf
    s_waitcnt vmcnt(5)
    s_add_u32 s58, s57, 0x6000
    buffer_load_dwordx4 v[88:91], v3, s[40:43], s58 offen nt
    v_add_u32 v61, 1, v61
    ds_write_b32 v63, v61
    ds_read_b32 v46, v63 offset:16
    v_mfma_f32_16x16x32_bf16 v[28:31], v[48:51], v[120:123], v[28:31]
    s_waitcnt vmcnt(5)
    s_add_u32 s58, s57, 0x7000
    buffer_load_dwordx4 v[92:95], v3, s[40:43], s58 offen nt
    v_mfma_f32_16x16x32_bf16 v[28:31], v[52:55], v[124:127], v[28:31]
    s_branch L_v_e
L_v_b3:
    v_mov_b32 v56, v57
    ds_read_b32 v57, v59
    v_add_u32 v59, 256, v59
    v_and_b32_dpp v48, v56, v8 row_newbcast:0 row_mask:0xf bank_mask:0xf
    v_and_b32_dpp v49, v56, v9 row_newbcast:0 row_mask:0xf bank_mask:0xf
    v_and_b32_dpp v50, v56, v10 row_newbcast:0 row_mask:0xf bank_mask:0xf
    v_and_b32_dpp v51, v56, v11 row_newbcast:0 row_mask:0xf bank_mask:0xf
    v_and_b32_dpp v52, v56, v8 row_newbcast:1 row_mask:0xf bank_mask:0xf
    v_and_b32_dpp v53, v56, v9 row_newbcast:1 row_mask:0xf bank_mask:0xf
    v_and_b32_dpp v54, v56, v10 row_newbcast:1 row_mask:0xf bank_mask:0xf
    v_and_b32_dpp v55, v56, v11 row_newbcast:1 row_mask:0xf bank_mask:0xf
    s_waitcnt vmcnt(6)
    s_add_u32 s58, s56, 0x10000
    buffer_load_dwordx4 v[96:99], v2, s[36:39], s58 offen nt
    v_add_u32 v61, 1, v61
    ds_write_b32 v63, v61
    v_mfma_f32_16x16x32_bf16 v[28:31], v[48:51], v[64:67], v[28:31]
    v_and_b32_dpp v48, v56, v8 row_newbcast:2 row_mask:0xf bank_mask:0xf
    v_and_b32_dpp v49, v56, v9 row_newbcast:2 row_mask:0xf bank_mask:0xf
    v_and_b32_dpp v50, v56, v10 row_newbcast:2 row_mask:0xf bank_mask:0xf
    v_and_b32_dpp v51, v56, v11 row_newbcast:2 row_mask:0xf bank_mask:0xf
    s_waitcnt vmcnt(6)
    s_add_u32 s58, s56, 0x11000
    buffer_load_dwordx4 v[100:103], v2, s[36:39], s58 offen nt
    v_mfma_f32_16x16x32_bf16 v[28:31], v[52:55], v[68:71], v[28:31]
    v_and_b32_dpp v52, v56, v8 row_newbcast:3 row_mask:0xf bank_mask:0xf
    v_and_b32_dpp v53, v56, v9 row_newbcast:3 row_mask:0xf bank_mask:0xf
    v_and_b32_dpp v54, v56, v10 row_newbcast:3 row_mask:0xf bank_mask:0xf
    v_and_b32_dpp v55, v56, v11 row_newbcast:3 row_mask:0xf bank_mask:0xf
    s_waitcnt vmcnt(6)
    s_add_u32 s58, s56, 0x12000
    buffer_load_dwordx4 v[104:107], v2, s[36:39], s58 offen nt
    v_add_u32 v61, 1, v61
    ds_write_b32 v63, v61
    v_mfma_f32_16x16x32_bf16 v[28:31], v[48:51], v[72:75], v[28:31]
    v_and_b32_dpp v48, v56, v8 row_newbcast:4 row_mask:0xf bank_mask:0xf
    v_and_b32_dpp v49, v56, v9 row_newbcast:4 row_mask:0xf bank_mask:0xf
    v_and_b32_dpp v50, v56, v10 row_newbcast:4 row_mask:0xf bank_mask:0xf
    v_and_b32_dpp v51, v56, v11 row_newbcast:4 row_mask:0xf bank_mask:0xf
    s_waitcnt vmcnt(6)
    s_add_u32 s58, s56, 0x13000
    buffer_load_dwordx4 v[108:111], v2, s[36:39], s58 offen nt
    v_mfma_f32_16x16x32_bf16 v[28:31], v[52:55], v[76:79], v[28:31]
    v_and_b32_dpp v52, v56, v8 row_newbcast:5 row_mask:0xf bank_mask:0xf
    v_and_b32_dpp v53, v56, v9 row_newbcast:5 row_mask:0xf bank_mask:0xf
    v_and_b32_dpp v54, v56, v10 row_newbcast:5 row_mask:0xf bank_mask:0xf
    v_and_b32_dpp v55, v56, v11 row_newbcast:5 row_mask:0xf bank_mask:0xf
    s_waitcnt vmcnt(6)
    s_add_u32 s58, s56, 0x14000
    buffer_load_dwordx4 v[112:115], v2, s[36:39], s58 offen nt
    v_add_u32 v61, 1, v61
    ds_write_b32 v63, v61
    v_mfma_f32_16x16x32_bf16 v[28:31], v[48:51], v[80:83], v[28:31]
    v_and_b32_dpp v48, v56, v8 row_newbcast:6 row_mask:0xf bank_mask:0xf
    v_and_b32_dpp v49, v56, v9 row_newbcast:6 row_mask:0xf bank_mask:0xf
    v_and_b32_dpp v50, v56, v10 row_newbcast:6 row_mask:0xf bank_mask:0xf
    v_and_b32_dpp v51, v56, v11 row_newbcast:6 row_mask:0xf bank_mask:0xf
    s_waitcnt vmcnt(6)
    s_add_u32 s58, s56, 0x15000
    buffer_load_dwordx4 v[116:119], v2, s[36:39], s58 offen nt
    v_mfma_f32_16x16x32_bf16 v[28:31], v[52:55], v[84:87], v[28:31]
    v_and_b32_dpp v52, v56, v8 row_newbcast:7 row_mask:0xf bank_mask:0xf
    v_and_b32_dpp v53, v56, v9 row_newbcast:7 row_mask:0xf bank_mask:0xf
    v_and_b32_dpp v54, v56, v10 row_newbcast:7 row_mask:0xf bank_mask:0xf
    v_and_b32_dpp v55, v56, v11 row_newbcast:7 row_mask:0xf bank_mask:0xf
    s_waitcnt vmcnt(6)
    s_add_u32 s58, s56, 0x16000
    buffer_load_dwordx4 v[120:123], v2, s[36:39], s58 offen nt
    v_add_u32 v61, 1, v61
    ds_write_b32 v63, v61
    ds_read_b32 v46, v63 offset:16
    v_mfma_f32_16x16x32_bf16 v[28:31], v[48:51], v[88:91], v[28:31]
    v_and_b32_dpp v48, v56, v8 row_newbcast:8 row_mask:0xf bank_mask:0xf
    v_and_b32_dpp v49, v56, v9 row_newbcast:8 row_mask:0xf bank_mask:0xf
    v_and_b32_dpp v50, v56, v10 row_newbcast:8 row_mask:0xf bank_mask:0xf
    v_and_b32_dpp v51, v56, v11 row_newbcast:8 row_mask:0xf bank_mask:0xf
    s_waitcnt vmcnt(6)
    s_add_u32 s58, s56, 0x17000
    buffer_load_dwordx4 v[124:127], v2, s[36:39], s58 offen nt
    v_mfma_f32_16x16x32_bf16 v[28:31], v[52:55], v[92:95], v[28:31]
    s_waitcnt lgkmcnt(0)
    v_readfirstlane_b32 s68, v46
    s_cmp_eq_u32 s68, 0
    s_cbranch_scc1 L_v_h0
    s_cmp_eq_u32 s68, 1
    s_cbranch_scc1 L_v_h1
    s_cmp_eq_u32 s68, 2
    s_cbranch_scc1 L_v_h2
L_v_h3:
    v_and_b32_dpp v52, v56, v8 row_newbcast:9 row_mask:0xf bank_mask:0xf
    v_and_b32_dpp v53, v56, v9 row_newbcast:9 row_mask:0xf bank_mask:0xf
    v_and_b32_dpp v54, v56, v10 row_newbcast:9 row_mask:0xf bank_mask:0xf
    v_and_b32_dpp v55, v56, v11 row_newbcast:9 row_mask:0xf bank_mask:0xf
    s_waitcnt vmcnt(6)
    s_add_u32 s58, s57, 0x0
    buffer_load_dwordx4 v[64:67], v3, s[40:43], s58 offen nt
    v_add_u32 v61, 1, v61
    ds_write_b32 v63, v61
    v_mfma_f32_16x16x32_bf16 v[28:31], v[48:51], v[96:99], v[28:31]
    v_and_b32_dpp v48, v56, v8 row_newbcast:10 row_mask:0xf bank_mask:0xf
    v_and_b32_dpp v49, v56, v9 row_newbcast:10 row_mask:0xf bank_mask:0xf
    v_and_b32_dpp v50, v56, v10 row_newbcast:10 row_mask:0xf bank_mask:0xf
    v_and_b32_dpp v51, v56, v11 row_newbcast:10 row_mask:0xf bank_mask:0xf
    s_waitcnt vmcnt(6)
    s_add_u32 s58, s57, 0x1000
    buffer_load_dwordx4 v[68:71], v3, s[40:43], s58 offen nt
    v_mfma_f32_16x16x32_bf16 v[28:31], v[52:55], v[100:103], v[28:31]
    v_and_b32_dpp v52, v56, v8 row_newbcast:11 row_mask:0xf bank_mask:0xf
    v_and_b32_dpp v53, v56, v9 row_newbcast:11 row_mask:0xf bank_mask:0xf
    v_and_b32_dpp v54, v56, v10 row_newbcast:11 row_mask:0xf bank_mask:0xf
    v_and_b32_dpp v55, v56, v11 row_newbcast:11 row_mask:0xf bank_mask:0xf
    s_waitcnt vmcnt(6)
    s_add_u32 s58, s57, 0x2000
    buffer_load_dwordx4 v[72:75], v3, s[40:43], s58 offen nt
    v_add_u32 v61, 1, v61
    ds_write_b32 v63, v61
    v_mfma_f32_16x16x32_bf16 v[28:31], v[48:51], v[104:107], v[28:31]
    v_and_b32_dpp v48, v56, v8 row_newbcast:12 row_mask:0xf bank_mask:0xf
    v_and_b32_dpp v49, v56, v9 row_newbcast:12 row_mask:0xf bank_mask:0xf
    v_and_b32_dpp v50, v56, v10 row_newbcast:12 row_mask:0xf bank_mask:0xf
    v_and_b32_dpp v51, v56, v11 row_newbcast:12 row_mask:0xf bank_mask:0xf
    s_waitcnt vmcnt(6)
    s_add_u32 s58, s57, 0x3000
    buffer_load_dwordx4 v[76:79], v3, s[40:43], s58 offen nt
    v_mfma_f32_16x16x32_bf16 v[28:31], v[52:55], v[108:111], v[28:31]
    v_and_b32_dpp v52, v56, v8 row_newbcast:13 row_mask:0xf bank_mask:0xf
    v_and_b32_dpp v53, v56, v9 row_newbcast:13 row_mask:0xf bank_mask:0xf
    v_and_b32_dpp v54, v56, v10 row_newbcast:13 row_mask:0xf bank_mask:0xf
    v_and_b32_dpp v55, v56, v11 row_newbcast:13 row_mask:0xf bank_mask:0xf
    s_waitcnt vmcnt(6)
    s_add_u32 s58, s57, 0x4000
    buffer_load_dwordx4 v[80:83], v3, s[40:43], s58 offen nt
    v_add_u32 v61, 1, v61
    ds_write_b32 v63, v61
    v_mfma_f32_16x16x32_bf16 v[28:31], v[48:51], v[112:115], v[28:31]
    v_and_b32_dpp v48, v56, v8 row_newbcast:14 row_mask:0xf bank_mask:0xf
    v_and_b32_dpp v49, v56, v9 row_newbcast:14 row_mask:0xf bank_mask:0xf
    v_and_b32_dpp v50, v56, v10 row_newbcast:14 row_mask:0xf bank_mask:0xf
    v_and_b32_dpp v51, v56, v11 row_newbcast:14 row_mask:0xf bank_mask:0xf
    s_waitcnt vmcnt(6)
    s_add_u32 s58, s57, 0x5000
    buffer_load_dwordx4 v[84:87], v3, s[40:43], s58 offen nt
    v_mfma_f32_16x16x32_bf16 v[28:31], v[52:55], v[116:119], v[28:31]
    v_and_b32_dpp v52, v56, v8 row_newbcast:15 row_mask:0xf bank_mask:0xf
    v_and_b32_dpp v53, v56, v9 row_newbcast:15 row_mask:0xf bank_mask:0xf
    v_and_b32_dpp v54, v56, v10 row_newbcast:15 row_mask:0xf bank_mask:0xf
    v_and_b32_dpp v55, v56, v11 row_newbcast:15 row_mask:0xf bank_mask:0xf
    s_waitcnt vmcnt(6)
    s_add_u32 s58, s57, 0x6000
    buffer_load_dwordx4 v[88:91], v3, s[40:43], s58 offen nt
    v_add_u32 v61, 1, v61
    ds_write_b32 v63, v61
    ds_read_b32 v46, v63 offset:16
    v_mfma_f32_16x16x32_bf16 v[28:31], v[48:51], v[120:123], v[28:31]
    s_waitcnt vmcnt(6)
    s_add_u32 s58, s57, 0x7000
    buffer_load_dwordx4 v[92:95], v3, s[40:43], s58 offen nt
    v_mfma_f32_16x16x32_bf16 v[28:31], v[52:55], v[124:127], v[28:31]
L_v_e:
    s_mov_b32 s56, s57
    s_add_u32 s59, s59, 1
    s_cmp_lt_u32 s59, 15
    s_cbranch_scc1 L_vloop
    s_waitcnt lgkmcnt(0)
    v_mov_b32 v56, v57
    ds_read_b32 v57, v59
    v_add_u32 v59, 256, v59
    v_and_b32_dpp v48, v56, v8 row_newbcast:0 row_mask:0xf bank_mask:0xf
    v_and_b32_dpp v49, v56, v9 row_newbcast:0 row_mask:0xf bank_mask:0xf
    v_and_b32_dpp v50, v56, v10 row_newbcast:0 row_mask:0xf bank_mask:0xf
    v_and_b32_dpp v51, v56, v11 row_newbcast:0 row_mask:0xf bank_mask:0xf
    v_and_b32_dpp v52, v56, v8 row_newbcast:1 row_mask:0xf bank_mask:0xf
    v_and_b32_dpp v53, v56, v9 row_newbcast:1 row_mask:0xf bank_mask:0xf
    v_and_b32_dpp v54, v56, v10 row_newbcast:1 row_mask:0xf bank_mask:0xf
    v_and_b32_dpp v55, v56, v11 row_newbcast:1 row_mask:0xf bank_mask:0xf
    s_waitcnt vmcnt(6)
    v_mfma_f32_16x16x32_bf16 v[28:31], v[48:51], v[64:67], v[28:31]
    s_add_u32 s58, s56, 0x10000
    buffer_load_dwordx4 v[96:99], v2, s[36:39], s58 offen nt
    v_and_b32_dpp v48, v56, v8 row_newbcast:2 row_mask:0xf bank_mask:0xf
    v_and_b32_dpp v49, v56, v9 row_newbcast:2 row_mask:0xf bank_mask:0xf
    v_and_b32_dpp v50, v56, v10 row_newbcast:2 row_mask:0xf bank_mask:0xf
    v_and_b32_dpp v51, v56, v11 row_newbcast:2 row_mask:0xf bank_mask:0xf
    s_waitcnt vmcnt(6)
    v_mfma_f32_16x16x32_bf16 v[28:31], v[52:55], v[68:71], v[28:31]
    s_add_u32 s58, s56, 0x11000
    buffer_load_dwordx4 v[100:103], v2, s[36:39], s58 offen nt
    v_and_b32_dpp v52, v56, v8 row_newbcast:3 row_mask:0xf bank_mask:0xf
    v_and_b32_dpp v53, v56, v9 row_newbcast:3 row_mask:0xf bank_mask:0xf
    v_and_b32_dpp v54, v56, v10 row_newbcast:3 row_mask:0xf bank_mask:0xf
    v_and_b32_dpp v55, v56, v11 row_newbcast:3 row_mask:0xf bank_mask:0xf
    s_waitcnt vmcnt(6)
    v_mfma_f32_16x16x32_bf16 v[28:31], v[48:51], v[72:75], v[28:31]
    s_add_u32 s58, s56, 0x12000
    buffer_load_dwordx4 v[104:107], v2, s[36:39], s58 offen nt
    v_and_b32_dpp v48, v56, v8 row_newbcast:4 row_mask:0xf bank_mask:0xf
    v_and_b32_dpp v49, v56, v9 row_newbcast:4 row_mask:0xf bank_mask:0xf
    v_and_b32_dpp v50, v56, v10 row_newbcast:4 row_mask:0xf bank_mask:0xf
    v_and_b32_dpp v51, v56, v11 row_newbcast:4 row_mask:0xf bank_mask:0xf
    s_waitcnt vmcnt(6)
    v_mfma_f32_16x16x32_bf16 v[28:31], v[52:55], v[76:79], v[28:31]
    s_add_u32 s58, s56, 0x13000
    buffer_load_dwordx4 v[108:111], v2, s[36:39], s58 offen nt
    v_and_b32_dpp v52, v56, v8 row_newbcast:5 row_mask:0xf bank_mask:0xf
    v_and_b32_dpp v53, v56, v9 row_newbcast:5 row_mask:0xf bank_mask:0xf
    v_and_b32_dpp v54, v56, v10 row_newbcast:5 row_mask:0xf bank_mask:0xf
    v_and_b32_dpp v55, v56, v11 row_newbcast:5 row_mask:0xf bank_mask:0xf
    s_waitcnt vmcnt(6)
    v_mfma_f32_16x16x32_bf16 v[28:31], v[48:51], v[80:83], v[28:31]
    s_add_u32 s58, s56, 0x14000
    buffer_load_dwordx4 v[112:115], v2, s[36:39], s58 offen nt
    v_and_b32_dpp v48, v56, v8 row_newbcast:6 row_mask:0xf bank_mask:0xf
    v_and_b32_dpp v49, v56, v9 row_newbcast:6 row_mask:0xf bank_mask:0xf
    v_and_b32_dpp v50, v56, v10 row_newbcast:6 row_mask:0xf bank_mask:0xf
    v_and_b32_dpp v51, v56, v11 row_newbcast:6 row_mask:0xf bank_mask:0xf
    s_waitcnt vmcnt(6)
    v_mfma_f32_16x16x32_bf16 v[28:31], v[52:55], v[84:87], v[28:31]
    s_add_u32 s58, s56, 0x15000
    buffer_load_dwordx4 v[116:119], v2, s[36:39], s58 offen nt
    v_and_b32_dpp v52, v56, v8 row_newbcast:7 row_mask:0xf bank_mask:0xf
    v_and_b32_dpp v53, v56, v9 row_newbcast:7 row_mask:0xf bank_mask:0xf
    v_and_b32_dpp v54, v56, v10 row_newbcast:7 row_mask:0xf bank_mask:0xf
    v_and_b32_dpp v55, v56, v11 row_newbcast:7 row_mask:0xf bank_mask:0xf
    s_waitcnt vmcnt(6)
    v_mfma_f32_16x16x32_bf16 v[28:31], v[48:51], v[88:91], v[28:31]
    s_add_u32 s58, s56, 0x16000
    buffer_load_dwordx4 v[120:123], v2, s[36:39], s58 offen nt
    v_and_b32_dpp v48, v56, v8 row_newbcast:8 row_mask:0xf bank_mask:0xf
    v_and_b32_dpp v49, v56, v9 row_newbcast:8 row_mask:0xf bank_mask:0xf
    v_and_b32_dpp v50, v56, v10 row_newbcast:8 row_mask:0xf bank_mask:0xf
    v_and_b32_dpp v51, v56, v11 row_newbcast:8 row_mask:0xf bank_mask:0xf
    s_waitcnt vmcnt(6)
    v_mfma_f32_16x16x32_bf16 v[28:31], v[52:55], v[92:95], v[28:31]
    s_add_u32 s58, s56, 0x17000
    buffer_load_dwordx4 v[124:127], v2, s[36:39], s58 offen nt
    v_and_b32_dpp v52, v56, v8 row_newbcast:9 row_mask:0xf bank_mask:0xf
    v_and_b32_dpp v53, v56, v9 row_newbcast:9 row_mask:0xf bank_mask:0xf
    v_and_b32_dpp v54, v56, v10 row_newbcast:9 row_mask:0xf bank_mask:0xf
    v_and_b32_dpp v55, v56, v11 row_newbcast:9 row_mask:0xf bank_mask:0xf
    s_waitcnt vmcnt(7)
    v_mfma_f32_16x16x32_bf16 v[28:31], v[48:51], v[96:99], v[28:31]
    v_and_b32_dpp v48, v56, v8 row_newbcast:10 row_mask:0xf bank_mask:0xf
    v_and_b32_dpp v49, v56, v9 row_newbcast:10 row_mask:0xf bank_mask:0xf
    v_and_b32_dpp v50, v56, v10 row_newbcast:10 row_mask:0xf bank_mask:0xf
    v_and_b32_dpp v51, v56, v11 row_newbcast:10 row_mask:0xf bank_mask:0xf
    s_waitcnt vmcnt(6)
    v_mfma_f32_16x16x32_bf16 v[28:31], v[52:55], v[100:103], v[28:31]
    v_and_b32_dpp v52, v56, v8 row_newbcast:11 row_mask:0xf bank_mask:0xf
    v_and_b32_dpp v53, v56, v9 row_newbcast:11 row_mask:0xf bank_mask:0xf
    v_and_b32_dpp v54, v56, v10 row_newbcast:11 row_mask:0xf bank_mask:0xf
    v_and_b32_dpp v55, v56, v11 row_newbcast:11 row_mask:0xf bank_mask:0xf
    s_waitcnt vmcnt(5)
    v_mfma_f32_16x16x32_bf16 v[28:31], v[48:51], v[104:107], v[28:31]
    v_and_b32_dpp v48, v56, v8 row_newbcast:12 row_mask:0xf bank_mask:0xf
    v_and_b32_dpp v49, v56, v9 row_newbcast:12 row_mask:0xf bank_mask:0xf
    v_and_b32_dpp v50, v56, v10 row_newbcast:12 row_mask:0xf bank_mask:0xf
    v_and_b32_dpp v51, v56, v11 row_newbcast:12 row_mask:0xf bank_mask:0xf
    s_waitcnt vmcnt(4)
    v_mfma_f32_16x16x32_bf16 v[28:31], v[52:55], v[108:111], v[28:31]
    v_and_b32_dpp v52, v56, v8 row_newbcast:13 row_mask:0xf bank_mask:0xf
    v_and_b32_dpp v53, v56, v9 row_newbcast:13 row_mask:0xf bank_mask:0xf
    v_and_b32_dpp v54, v56, v10 row_newbcast:13 row_mask:0xf bank_mask:0xf
    v_and_b32_dpp v55, v56, v11 row_newbcast:13 row_mask:0xf bank_mask:0xf
    s_waitcnt vmcnt(3)
    v_mfma_f32_16x16x32_bf16 v[28:31], v[48:51], v[112:115], v[28:31]
    v_and_b32_dpp v48, v56, v8 row_newbcast:14 row_mask:0xf bank_mask:0xf
    v_and_b32_dpp v49, v56, v9 row_newbcast:14 row_mask:0xf bank_mask:0xf
    v_and_b32_dpp v50, v56, v10 row_newbcast:14 row_mask:0xf bank_mask:0xf
    v_and_b32_dpp v51, v56, v11 row_newbcast:14 row_mask:0xf bank_mask:0xf
    s_waitcnt vmcnt(2)
    v_mfma_f32_16x16x32_bf16 v[28:31], v[52:55], v[116:119], v[28:31]
    v_and_b32_dpp v52, v56, v8 row_newbcast:15 row_mask:0xf bank_mask:0xf
    v_and_b32_dpp v53, v56, v9 row_newbcast:15 row_mask:0xf bank_mask:0xf
    v_and_b32_dpp v54, v56, v10 row_newbcast:15 row_mask:0xf bank_mask:0xf
    v_and_b32_dpp v55, v56, v11 row_newbcast:15 row_mask:0xf bank_mask:0xf
    s_waitcnt vmcnt(1)
    v_mfma_f32_16x16x32_bf16 v[28:31], v[48:51], v[120:123], v[28:31]
    s_waitcnt vmcnt(0)
    v_mfma_f32_16x16x32_bf16 v[28:31], v[52:55], v[124:127], v[28:31]
    s_mov_b32 exec_hi, 0
    s_nop 6
    v_cvt_pk_bf16_f32 v32, v28, v29
    v_cvt_pk_bf16_f32 v33, v30, v31
    ds_write_b64 v60, v[32:33] offset:2048
    s_waitcnt lgkmcnt(0)
    s_barrier
    s_endpgm
L_aux:
    s_sub_u32 s33, s28, 4
    s_cmp_eq_u32 s33, 0
    s_cbranch_scc1 L_qw
    s_cmp_eq_u32 s33, 1
    s_cbranch_scc1 L_fw
    v_mov_b32 v38, 320
    v_mov_b32 v40, 0
    ds_write_b32 v38, v40
    v_lshlrev_b32 v39, 2, v1
    ds_write_b32 v39, v40 offset:512
    v_mov_b32 v41, 0
    v_mov_b32 v42, 0
    v_mov_b32 v43, 0
    v_mov_b32 v44, 1
    v_mov_b32 v45, 1
    v_mov_b32 v46, 1
    v_mov_b32 v47, 1
    ds_write_b128 v38, v[40:43] offset:16
    ds_write_b128 v38, v[44:47] offset:32
    s_waitcnt lgkmcnt(0)
    s_mov_b32 s44, s26
    s_mov_b32 s45, s27
    s_mov_b32 s46, 0x500000
    s_mov_b32 s47, 0x00020000
    s_cmp_eq_u32 s33, 2
    s_cbranch_scc0 L_nz0
    s_and_b32 s56, s2, 7
    s_lshl_b32 s56, s56, 8
    s_lshr_b32 s57, s2, 3
    s_lshl_b32 s57, s57, 2
    s_add_u32 s57, s57, s56
    s_add_u32 s57, s57, 0xca000
    s_mov_b64 exec, 1
    buffer_store_dword v40, v4, s[44:47], s57 offen
    s_mov_b64 exec, -1
L_nz0:
    s_branch L_bar1
L_fw:
    v_mul_u32_u24 v38, 28672, v5
    v_and_b32 v39, 7, v6
    v_lshl_add_u32 v2, v39, 4, v38
    s_mul_i32 s66, s34, 229376
    s_lshl_b32 s58, s30, 7
    s_add_u32 s66, s66, s58
    s_mov_b32 s62, 0x00ff00ff
    s_mov_b32 s63, 0x00ff00ff
    s_waitcnt lgkmcnt(0)
    s_mov_b32 s44, s26
    s_mov_b32 s45, s27
    s_mov_b32 s46, 0x500000
    s_mov_b32 s47, 0x00020000
    s_cmp_lt_u32 s30, 28
    s_cbranch_scc0 L_bar1
    s_mov_b32 s36, s16
    s_mov_b32 s37, s17
    s_mov_b32 s38, 0x1c0000
    s_mov_b32 s39, 0x00020000
    s_mov_b32 s40, s18
    s_mov_b32 s41, s19
    s_mov_b32 s42, 0x1c0000
    s_mov_b32 s43, 0x00020000
    s_mov_b64 exec, s[62:63]
    s_add_u32 s58, s66, 0x0
    buffer_load_dwordx4 v[64:67], v2, s[36:39], s58 offen nt
    s_add_u32 s58, s66, 0xe00
    buffer_load_dwordx4 v[68:71], v2, s[36:39], s58 offen nt
    s_add_u32 s58, s66, 0x1c00
    buffer_load_dwordx4 v[72:75], v2, s[36:39], s58 offen nt
    s_add_u32 s58, s66, 0x2a00
    buffer_load_dwordx4 v[76:79], v2, s[36:39], s58 offen nt
    s_add_u32 s58, s66, 0x3800
    buffer_load_dwordx4 v[80:83], v2, s[36:39], s58 offen nt
    s_add_u32 s58, s66, 0x4600
    buffer_load_dwordx4 v[84:87], v2, s[36:39], s58 offen nt
    s_add_u32 s58, s66, 0x5400
    buffer_load_dwordx4 v[88:91], v2, s[36:39], s58 offen nt
    s_add_u32 s58, s66, 0x6200
    buffer_load_dwordx4 v[92:95], v2, s[36:39], s58 offen nt
    s_add_u32 s58, s66, 0x1c000
    buffer_load_dwordx4 v[96:99], v2, s[36:39], s58 offen nt
    s_add_u32 s58, s66, 0x1ce00
    buffer_load_dwordx4 v[100:103], v2, s[36:39], s58 offen nt
    s_add_u32 s58, s66, 0x1dc00
    buffer_load_dwordx4 v[104:107], v2, s[36:39], s58 offen nt
    s_add_u32 s58, s66, 0x1ea00
    buffer_load_dwordx4 v[108:111], v2, s[36:39], s58 offen nt
    s_add_u32 s58, s66, 0x1f800
    buffer_load_dwordx4 v[112:115], v2, s[36:39], s58 offen nt
    s_add_u32 s58, s66, 0x20600
    buffer_load_dwordx4 v[116:119], v2, s[36:39], s58 offen nt
    s_add_u32 s58, s66, 0x21400
    buffer_load_dwordx4 v[120:123], v2, s[36:39], s58 offen nt
    s_add_u32 s58, s66, 0x22200
    buffer_load_dwordx4 v[124:127], v2, s[36:39], s58 offen nt
    s_not_b64 exec, s[62:63]
    s_add_u32 s58, s66, 0x0
    buffer_load_dwordx4 v[64:67], v2, s[40:43], s58 offen nt
    s_add_u32 s58, s66, 0xe00
    buffer_load_dwordx4 v[68:71], v2, s[40:43], s58 offen nt
    s_add_u32 s58, s66, 0x1c00
    buffer_load_dwordx4 v[72:75], v2, s[40:43], s58 offen nt
    s_add_u32 s58, s66, 0x2a00
    buffer_load_dwordx4 v[76:79], v2, s[40:43], s58 offen nt
    s_add_u32 s58, s66, 0x3800
    buffer_load_dwordx4 v[80:83], v2, s[40:43], s58 offen nt
    s_add_u32 s58, s66, 0x4600
    buffer_load_dwordx4 v[84:87], v2, s[40:43], s58 offen nt
    s_add_u32 s58, s66, 0x5400
    buffer_load_dwordx4 v[88:91], v2, s[40:43], s58 offen nt
    s_add_u32 s58, s66, 0x6200
    buffer_load_dwordx4 v[92:95], v2, s[40:43], s58 offen nt
    s_add_u32 s58, s66, 0x1c000
    buffer_load_dwordx4 v[96:99], v2, s[40:43], s58 offen nt
    s_add_u32 s58, s66, 0x1ce00
    buffer_load_dwordx4 v[100:103], v2, s[40:43], s58 offen nt
    s_add_u32 s58, s66, 0x1dc00
    buffer_load_dwordx4 v[104:107], v2, s[40:43], s58 offen nt
    s_add_u32 s58, s66, 0x1ea00
    buffer_load_dwordx4 v[108:111], v2, s[40:43], s58 offen nt
    s_add_u32 s58, s66, 0x1f800
    buffer_load_dwordx4 v[112:115], v2, s[40:43], s58 offen nt
    s_add_u32 s58, s66, 0x20600
    buffer_load_dwordx4 v[116:119], v2, s[40:43], s58 offen nt
    s_add_u32 s58, s66, 0x21400
    buffer_load_dwordx4 v[120:123], v2, s[40:43], s58 offen nt
    s_add_u32 s58, s66, 0x22200
    buffer_load_dwordx4 v[124:127], v2, s[40:43], s58 offen nt
    s_mov_b64 exec, -1
    s_branch L_bar1
L_qw:
    s_setprio 3
    v_lshrrev_b32 v38, 2, v6
    v_lshlrev_b32 v38, 10, v38
    v_and_b32 v39, 3, v6
    v_lshlrev_b32 v39, 6, v39
    v_lshlrev_b32 v40, 8, v5
    v_add3_u32 v3, v38, v39, v40
    v_lshl_add_u32 v59, v5, 4, v38
    v_lshlrev_b32 v38, 16, v5
    v_lshl_add_u32 v2, v6, 4, v38
    v_mov_b32 v60, 0
    s_lshl_b32 s60, s34, 7
    s_lshl_b32 s66, s34, 19
    s_lshl_b32 s58, s30, 8
    s_add_u32 s66, s66, s58
    s_lshl_b32 s61, s30, 7
    s_add_u32 s61, s61, 0xc8000
    s_waitcnt lgkmcnt(0)
    s_mov_b32 s36, s4
    s_mov_b32 s37, s5
    s_mov_b32 s38, 0x1000
    s_mov_b32 s39, 0x00020000
    buffer_load_dwordx4 v[128:131], v3, s[36:39], 0 offen offset:0
    buffer_load_dwordx4 v[132:135], v3, s[36:39], 0 offen offset:16
    buffer_load_dwordx4 v[136:139], v3, s[36:39], 0 offen offset:32
    buffer_load_dwordx4 v[140:143], v3, s[36:39], 0 offen offset:48
    buffer_load_dwordx4 v[12:15], v59, s[36:39], s60 offen offset:0
    buffer_load_dwordx4 v[16:19], v59, s[36:39], s60 offen offset:64
    s_mov_b32 s40, s10
    s_mov_b32 s41, s11
    s_mov_b32 s42, 0x400000
    s_mov_b32 s43, 0x00020000
    s_add_u32 s58, s66, 0x0
    buffer_load_dwordx4 v[64:67], v2, s[40:43], s58 offen nt
    s_add_u32 s58, s66, 0x2000
    buffer_load_dwordx4 v[68:71], v2, s[40:43], s58 offen nt
    s_add_u32 s58, s66, 0x4000
    buffer_load_dwordx4 v[72:75], v2, s[40:43], s58 offen nt
    s_add_u32 s58, s66, 0x6000
    buffer_load_dwordx4 v[76:79], v2, s[40:43], s58 offen nt
    s_add_u32 s58, s66, 0x8000
    buffer_load_dwordx4 v[80:83], v2, s[40:43], s58 offen nt
    s_add_u32 s58, s66, 0xa000
    buffer_load_dwordx4 v[84:87], v2, s[40:43], s58 offen nt
    s_add_u32 s58, s66, 0xc000
    buffer_load_dwordx4 v[88:91], v2, s[40:43], s58 offen nt
    s_add_u32 s58, s66, 0xe000
    buffer_load_dwordx4 v[92:95], v2, s[40:43], s58 offen nt
    s_add_u32 s58, s66, 0x40000
    buffer_load_dwordx4 v[96:99], v2, s[40:43], s58 offen nt
    s_add_u32 s58, s66, 0x42000
    buffer_load_dwordx4 v[100:103], v2, s[40:43], s58 offen nt
    s_add_u32 s58, s66, 0x44000
    buffer_load_dwordx4 v[104:107], v2, s[40:43], s58 offen nt
    s_add_u32 s58, s66, 0x46000
    buffer_load_dwordx4 v[108:111], v2, s[40:43], s58 offen nt
    s_add_u32 s58, s66, 0x48000
    buffer_load_dwordx4 v[112:115], v2, s[40:43], s58 offen nt
    s_add_u32 s58, s66, 0x4a000
    buffer_load_dwordx4 v[116:119], v2, s[40:43], s58 offen nt
    s_add_u32 s58, s66, 0x4c000
    buffer_load_dwordx4 v[120:123], v2, s[40:43], s58 offen nt
    s_add_u32 s58, s66, 0x4e000
    buffer_load_dwordx4 v[124:127], v2, s[40:43], s58 offen nt
    s_mov_b32 s44, s26
    s_mov_b32 s45, s27
    s_mov_b32 s46, 0x500000
    s_mov_b32 s47, 0x00020000
    buffer_load_dwordx2 v[20:21], v60, s[44:47], s61 offen sc1
    s_waitcnt vmcnt(19)
    v_lshlrev_b32 v144, 16, v128
    v_and_b32 v145, 0xffff0000, v128
    v_lshlrev_b32 v146, 16, v129
    v_and_b32 v147, 0xffff0000, v129
    v_lshlrev_b32 v148, 16, v130
    v_and_b32 v149, 0xffff0000, v130
    v_lshlrev_b32 v150, 16, v131
    v_and_b32 v151, 0xffff0000, v131
    v_lshlrev_b32 v152, 16, v132
    v_and_b32 v153, 0xffff0000, v132
    v_lshlrev_b32 v154, 16, v133
    v_and_b32 v155, 0xffff0000, v133
    v_lshlrev_b32 v156, 16, v134
    v_and_b32 v157, 0xffff0000, v134
    v_lshlrev_b32 v158, 16, v135
    v_and_b32 v159, 0xffff0000, v135
    v_lshlrev_b32 v160, 16, v136
    v_and_b32 v161, 0xffff0000, v136
    v_lshlrev_b32 v162, 16, v137
    v_and_b32 v163, 0xffff0000, v137
    v_lshlrev_b32 v164, 16, v138
    v_and_b32 v165, 0xffff0000, v138
    v_lshlrev_b32 v166, 16, v139
    v_and_b32 v167, 0xffff0000, v139
    v_lshlrev_b32 v168, 16, v140
    v_and_b32 v169, 0xffff0000, v140
    v_lshlrev_b32 v170, 16, v141
    v_and_b32 v171, 0xffff0000, v141
    v_lshlrev_b32 v172, 16, v142
    v_and_b32 v173, 0xffff0000, v142
    v_lshlrev_b32 v174, 16, v143
    v_and_b32 v175, 0xffff0000, v143
    v_pk_add_f32 v[128:129], v[144:145], v[146:147]
    v_pk_add_f32 v[130:131], v[148:149], v[150:151]
    v_pk_add_f32 v[132:133], v[152:153], v[154:155]
    v_pk_add_f32 v[134:135], v[156:157], v[158:159]
    v_pk_add_f32 v[136:137], v[160:161], v[162:163]
    v_pk_add_f32 v[138:139], v[164:165], v[166:167]
    v_pk_add_f32 v[140:141], v[168:169], v[170:171]
    v_pk_add_f32 v[142:143], v[172:173], v[174:175]
    v_pk_add_f32 v[128:129], v[128:129], v[136:137]
    v_pk_add_f32 v[130:131], v[130:131], v[138:139]
    v_pk_add_f32 v[132:133], v[132:133], v[140:141]
    v_pk_add_f32 v[134:135], v[134:135], v[142:143]
    v_pk_add_f32 v[128:129], v[128:129], v[132:133]
    v_pk_add_f32 v[130:131], v[130:131], v[134:135]
    v_pk_add_f32 v[128:129], v[128:129], v[130:131]
    v_add_f32 v38, v128, v129
    s_nop 1
    v_add_f32_dpp v38, v38, v38 quad_perm:[1,0,3,2] row_mask:0xf bank_mask:0xf
    s_nop 1
    v_add_f32_dpp v38, v38, v38 quad_perm:[2,3,0,1] row_mask:0xf bank_mask:0xf
    s_nop 0
    v_mov_b32 v39, v38
    s_nop 1
    v_permlane16_swap_b32 v38, v39
    s_nop 0
    v_add_f32 v38, v38, v39
    s_nop 0
    v_mov_b32 v39, v38
    s_nop 1
    v_permlane32_swap_b32 v38, v39
    s_nop 0
    v_add_f32 v38, v38, v39
    v_mul_f32 v38, 0x3b000000, v38
    v_mov_b32 v39, v38
    v_pk_add_f32 v[144:145], v[144:145], v[38:39] neg_lo:[0,1] neg_hi:[0,1]
    v_pk_add_f32 v[146:147], v[146:147], v[38:39] neg_lo:[0,1] neg_hi:[0,1]
    v_pk_add_f32 v[148:149], v[148:149], v[38:39] neg_lo:[0,1] neg_hi:[0,1]
    v_pk_add_f32 v[150:151], v[150:151], v[38:39] neg_lo:[0,1] neg_hi:[0,1]
    v_pk_add_f32 v[152:153], v[152:153], v[38:39] neg_lo:[0,1] neg_hi:[0,1]
    v_pk_add_f32 v[154:155], v[154:155], v[38:39] neg_lo:[0,1] neg_hi:[0,1]
    v_pk_add_f32 v[156:157], v[156:157], v[38:39] neg_lo:[0,1] neg_hi:[0,1]
    v_pk_add_f32 v[158:159], v[158:159], v[38:39] neg_lo:[0,1] neg_hi:[0,1]
    v_pk_add_f32 v[160:161], v[160:161], v[38:39] neg_lo:[0,1] neg_hi:[0,1]
    v_pk_add_f32 v[162:163], v[162:163], v[38:39] neg_lo:[0,1] neg_hi:[0,1]
    v_pk_add_f32 v[164:165], v[164:165], v[38:39] neg_lo:[0,1] neg_hi:[0,1]
    v_pk_add_f32 v[166:167], v[166:167], v[38:39] neg_lo:[0,1] neg_hi:[0,1]
    v_pk_add_f32 v[168:169], v[168:169], v[38:39] neg_lo:[0,1] neg_hi:[0,1]
    v_pk_add_f32 v[170:171], v[170:171], v[38:39] neg_lo:[0,1] neg_hi:[0,1]
    v_pk_add_f32 v[172:173], v[172:173], v[38:39] neg_lo:[0,1] neg_hi:[0,1]
    v_pk_add_f32 v[174:175], v[174:175], v[38:39] neg_lo:[0,1] neg_hi:[0,1]
    v_pk_mul_f32 v[128:129], v[144:145], v[144:145]
    v_pk_mul_f32 v[130:131], v[146:147], v[146:147]
    v_pk_fma_f32 v[128:129], v[148:149], v[148:149], v[128:129]
    v_pk_fma_f32 v[130:131], v[150:151], v[150:151], v[130:131]
    v_pk_fma_f32 v[128:129], v[152:153], v[152:153], v[128:129]
    v_pk_fma_f32 v[130:131], v[154:155], v[154:155], v[130:131]
    v_pk_fma_f32 v[128:129], v[156:157], v[156:157], v[128:129]
    v_pk_fma_f32 v[130:131], v[158:159], v[158:159], v[130:131]
    v_pk_fma_f32 v[128:129], v[160:161], v[160:161], v[128:129]
    v_pk_fma_f32 v[130:131], v[162:163], v[162:163], v[130:131]
    v_pk_fma_f32 v[128:129], v[164:165], v[164:165], v[128:129]
    v_pk_fma_f32 v[130:131], v[166:167], v[166:167], v[130:131]
    v_pk_fma_f32 v[128:129], v[168:169], v[168:169], v[128:129]
    v_pk_fma_f32 v[130:131], v[170:171], v[170:171], v[130:131]
    v_pk_fma_f32 v[128:129], v[172:173], v[172:173], v[128:129]
    v_pk_fma_f32 v[130:131], v[174:175], v[174:175], v[130:131]
    v_pk_add_f32 v[128:129], v[128:129], v[130:131]
    v_add_f32 v40, v128, v129
    s_nop 1
    v_add_f32_dpp v40, v40, v40 quad_perm:[1,0,3,2] row_mask:0xf bank_mask:0xf
    s_nop 1
    v_add_f32_dpp v40, v40, v40 quad_perm:[2,3,0,1] row_mask:0xf bank_mask:0xf
    s_nop 0
    v_mov_b32 v39, v40
    s_nop 1
    v_permlane16_swap_b32 v40, v39
    s_nop 0
    v_add_f32 v40, v40, v39
    s_nop 0
    v_mov_b32 v39, v40
    s_nop 1
    v_permlane32_swap_b32 v40, v39
    s_nop 0
    v_add_f32 v40, v40, v39
    v_mul_f32 v40, 0x3b000000, v40
    v_cvt_pk_bf16_f32 v39, v38, v38
    v_and_b32 v38, 0xffff0000, v39
    v_cvt_pk_bf16_f32 v39, v40, v40
    v_and_b32 v40, 0xffff0000, v39
    v_add_f32 v40, 0x3727c5ac, v40
    v_cvt_pk_bf16_f32 v39, v40, v40
    v_and_b32 v40, 0xffff0000, v39
    v_sqrt_f32 v40, v40
    s_nop 0
    v_cvt_pk_bf16_f32 v39, v40, v40
    v_and_b32 v40, 0xffff0000, v39
    v_rcp_f32 v40, v40
    s_waitcnt vmcnt(17)
    v_lshlrev_b32 v144, 16, v12
    v_and_b32 v145, 0xffff0000, v12
    v_lshlrev_b32 v146, 16, v13
    v_and_b32 v147, 0xffff0000, v13
    v_lshlrev_b32 v148, 16, v14
    v_and_b32 v149, 0xffff0000, v14
    v_lshlrev_b32 v150, 16, v15
    v_and_b32 v151, 0xffff0000, v15
    v_lshlrev_b32 v152, 16, v16
    v_and_b32 v153, 0xffff0000, v16
    v_lshlrev_b32 v154, 16, v17
    v_and_b32 v155, 0xffff0000, v17
    v_lshlrev_b32 v156, 16, v18
    v_and_b32 v157, 0xffff0000, v18
    v_lshlrev_b32 v158, 16, v19
    v_and_b32 v159, 0xffff0000, v19
    v_sub_f32 v144, v144, v38
    v_sub_f32 v145, v145, v38
    v_sub_f32 v146, v146, v38
    v_sub_f32 v147, v147, v38
    v_sub_f32 v148, v148, v38
    v_sub_f32 v149, v149, v38
    v_sub_f32 v150, v150, v38
    v_sub_f32 v151, v151, v38
    v_sub_f32 v152, v152, v38
    v_sub_f32 v153, v153, v38
    v_sub_f32 v154, v154, v38
    v_sub_f32 v155, v155, v38
    v_sub_f32 v156, v156, v38
    v_sub_f32 v157, v157, v38
    v_sub_f32 v158, v158, v38
    v_sub_f32 v159, v159, v38
    v_cvt_pk_bf16_f32 v12, v144, v145
    v_cvt_pk_bf16_f32 v13, v146, v147
    v_cvt_pk_bf16_f32 v14, v148, v149
    v_cvt_pk_bf16_f32 v15, v150, v151
    v_cvt_pk_bf16_f32 v16, v152, v153
    v_cvt_pk_bf16_f32 v17, v154, v155
    v_cvt_pk_bf16_f32 v18, v156, v157
    v_cvt_pk_bf16_f32 v19, v158, v159
    v_lshlrev_b32 v144, 16, v12
    v_and_b32 v145, 0xffff0000, v12
    v_lshlrev_b32 v146, 16, v13
    v_and_b32 v147, 0xffff0000, v13
    v_lshlrev_b32 v148, 16, v14
    v_and_b32 v149, 0xffff0000, v14
    v_lshlrev_b32 v150, 16, v15
    v_and_b32 v151, 0xffff0000, v15
    v_lshlrev_b32 v152, 16, v16
    v_and_b32 v153, 0xffff0000, v16
    v_lshlrev_b32 v154, 16, v17
    v_and_b32 v155, 0xffff0000, v17
    v_lshlrev_b32 v156, 16, v18
    v_and_b32 v157, 0xffff0000, v18
    v_lshlrev_b32 v158, 16, v19
    v_and_b32 v159, 0xffff0000, v19
    v_mul_f32 v144, v144, v40
    v_mul_f32 v145, v145, v40
    v_mul_f32 v146, v146, v40
    v_mul_f32 v147, v147, v40
    v_mul_f32 v148, v148, v40
    v_mul_f32 v149, v149, v40
    v_mul_f32 v150, v150, v40
    v_mul_f32 v151, v151, v40
    v_mul_f32 v152, v152, v40
    v_mul_f32 v153, v153, v40
    v_mul_f32 v154, v154, v40
    v_mul_f32 v155, v155, v40
    v_mul_f32 v156, v156, v40
    v_mul_f32 v157, v157, v40
    v_mul_f32 v158, v158, v40
    v_mul_f32 v159, v159, v40
    v_cvt_pk_bf16_f32 v12, v144, v145
    v_cvt_pk_bf16_f32 v13, v146, v147
    v_cvt_pk_bf16_f32 v14, v148, v149
    v_cvt_pk_bf16_f32 v15, v150, v151
    v_cvt_pk_bf16_f32 v16, v152, v153
    v_cvt_pk_bf16_f32 v17, v154, v155
    v_cvt_pk_bf16_f32 v18, v156, v157
    v_cvt_pk_bf16_f32 v19, v158, v159
    s_mov_b32 s62, 0x05040100
    s_mov_b32 s63, 0x07060302
    s_waitcnt vmcnt(9)
    v_perm_b32 v48, v68, v64, s62
    v_perm_b32 v49, v76, v72, s62
    v_perm_b32 v50, v84, v80, s62
    v_perm_b32 v51, v92, v88, s62
    v_perm_b32 v52, v68, v64, s63
    v_perm_b32 v53, v76, v72, s63
    v_perm_b32 v54, v84, v80, s63
    v_perm_b32 v55, v92, v88, s63
    v_mfma_f32_16x16x32_bf16 v[192:195], v[12:15], v[48:51], 0
    v_perm_b32 v48, v69, v65, s62
    v_perm_b32 v49, v77, v73, s62
    v_perm_b32 v50, v85, v81, s62
    v_perm_b32 v51, v93, v89, s62
    v_mfma_f32_16x16x32_bf16 v[196:199], v[12:15], v[52:55], 0
    v_perm_b32 v52, v69, v65, s63
    v_perm_b32 v53, v77, v73, s63
    v_perm_b32 v54, v85, v81, s63
    v_perm_b32 v55, v93, v89, s63
    v_mfma_f32_16x16x32_bf16 v[200:203], v[12:15], v[48:51], 0
    v_perm_b32 v48, v70, v66, s62
    v_perm_b32 v49, v78, v74, s62
    v_perm_b32 v50, v86, v82, s62
    v_perm_b32 v51, v94, v90, s62
    v_mfma_f32_16x16x32_bf16 v[204:207], v[12:15], v[52:55], 0
    v_perm_b32 v52, v70, v66, s63
    v_perm_b32 v53, v78, v74, s63
    v_perm_b32 v54, v86, v82, s63
    v_perm_b32 v55, v94, v90, s63
    v_mfma_f32_16x16x32_bf16 v[208:211], v[12:15], v[48:51], 0
    v_perm_b32 v48, v71, v67, s62
    v_perm_b32 v49, v79, v75, s62
    v_perm_b32 v50, v87, v83, s62
    v_perm_b32 v51, v95, v91, s62
    v_mfma_f32_16x16x32_bf16 v[212:215], v[12:15], v[52:55], 0
    v_perm_b32 v52, v71, v67, s63
    v_perm_b32 v53, v79, v75, s63
    v_perm_b32 v54, v87, v83, s63
    v_perm_b32 v55, v95, v91, s63
    v_mfma_f32_16x16x32_bf16 v[216:219], v[12:15], v[48:51], 0
    s_waitcnt vmcnt(1)
    v_perm_b32 v48, v100, v96, s62
    v_perm_b32 v49, v108, v104, s62
    v_perm_b32 v50, v116, v112, s62
    v_perm_b32 v51, v124, v120, s62
    v_mfma_f32_16x16x32_bf16 v[220:223], v[12:15], v[52:55], 0
    v_perm_b32 v52, v100, v96, s63
    v_perm_b32 v53, v108, v104, s63
    v_perm_b32 v54, v116, v112, s63
    v_perm_b32 v55, v124, v120, s63
    v_mfma_f32_16x16x32_bf16 v[192:195], v[16:19], v[48:51], v[192:195]
    v_perm_b32 v48, v101, v97, s62
    v_perm_b32 v49, v109, v105, s62
    v_perm_b32 v50, v117, v113, s62
    v_perm_b32 v51, v125, v121, s62
    v_mfma_f32_16x16x32_bf16 v[196:199], v[16:19], v[52:55], v[196:199]
    v_perm_b32 v52, v101, v97, s63
    v_perm_b32 v53, v109, v105, s63
    v_perm_b32 v54, v117, v113, s63
    v_perm_b32 v55, v125, v121, s63
    v_mfma_f32_16x16x32_bf16 v[200:203], v[16:19], v[48:51], v[200:203]
    v_perm_b32 v48, v102, v98, s62
    v_perm_b32 v49, v110, v106, s62
    v_perm_b32 v50, v118, v114, s62
    v_perm_b32 v51, v126, v122, s62
    v_mfma_f32_16x16x32_bf16 v[204:207], v[16:19], v[52:55], v[204:207]
    v_perm_b32 v52, v102, v98, s63
    v_perm_b32 v53, v110, v106, s63
    v_perm_b32 v54, v118, v114, s63
    v_perm_b32 v55, v126, v122, s63
    v_mfma_f32_16x16x32_bf16 v[208:211], v[16:19], v[48:51], v[208:211]
    v_perm_b32 v48, v103, v99, s62
    v_perm_b32 v49, v111, v107, s62
    v_perm_b32 v50, v119, v115, s62
    v_perm_b32 v51, v127, v123, s62
    v_mfma_f32_16x16x32_bf16 v[212:215], v[16:19], v[52:55], v[212:215]
    v_perm_b32 v52, v103, v99, s63
    v_perm_b32 v53, v111, v107, s63
    v_perm_b32 v54, v119, v115, s63
    v_perm_b32 v55, v127, v123, s63
    v_mfma_f32_16x16x32_bf16 v[216:219], v[16:19], v[48:51], v[216:219]
    s_nop 1
    v_mfma_f32_16x16x32_bf16 v[220:223], v[16:19], v[52:55], v[220:223]
    s_waitcnt vmcnt(0)
    v_mov_b32 v38, 0x9e3779b9
    v_add_co_u32 v20, vcc, 0x7f4a7c15, v20
    s_nop 1
    v_addc_co_u32 v21, vcc, v38, v21, vcc
    s_getreg_b32 s59, hwreg(HW_REG_XCC_ID)
    s_and_b32 s59, s59, 15
    s_add_u32 s59, s59, 1
    s_lshl_b32 s59, s59, 20
    v_xor_b32 v22, s59, v21
    v_lshlrev_b32 v3, 13, v5
    v_lshl_add_u32 v3, v6, 4, v3
    s_lshl_b32 s56, s30, 15
    s_add_u32 s56, s56, 0x100000
    s_lshl_b32 s58, s34, 10
    s_add_u32 s58, s58, s56
    s_add_u32 s66, s58, 0x100000
    s_nop 2
    v_mov_b32 v193, v196
    v_mov_b32 v194, v20
    v_mov_b32 v195, v22
    buffer_store_dwordx4 v[192:195], v3, s[44:47], s58 offen offset:0
    v_mov_b32 v201, v204
    v_mov_b32 v202, v20
    v_mov_b32 v203, v22
    buffer_store_dwordx4 v[200:203], v3, s[44:47], s58 offen offset:256
    v_mov_b32 v209, v212
    v_mov_b32 v210, v20
    v_mov_b32 v211, v22
    buffer_store_dwordx4 v[208:211], v3, s[44:47], s58 offen offset:512
    v_mov_b32 v217, v220
    v_mov_b32 v218, v20
    v_mov_b32 v219, v22
    buffer_store_dwordx4 v[216:219], v3, s[44:47], s58 offen offset:768
    ds_write_b128 v4, v[12:15] offset:4096
    ds_write_b128 v4, v[16:19] offset:5120
    ds_write_b64 v60, v[20:21] offset:256
    s_lshl_b32 s58, s29, 13
    s_add_u32 s56, s56, s58
    s_add_u32 s57, s56, 4096
    s_mov_b32 s67, 0
    v_lshlrev_b32 v41, 10, v1
    v_add_u32 v41, 1008, v41
    s_mov_b64 exec, 0xff
L_ql:
    buffer_load_dwordx4 v[64:67], v41, s[44:47], s56 offen sc1
    s_add_u32 s67, s67, 1
    s_waitcnt vmcnt(0)
    v_xor_b32 v39, v66, v20
    v_xor_b32 v40, v67, v22
    v_or_b32 v38, v39, v40
    v_cmp_ne_u32 vcc, 0, v38
    s_nop 1
    s_cmp_eq_u64 vcc, 0
    s_cbranch_scc1 L_ql_ok
    s_cmp_lt_u32 s67, 7
    s_cbranch_scc1 L_ql
L_ql_ok:
    s_mov_b64 exec, -1
L_qp:
    buffer_load_dwordx4 v[64:67], v4, s[44:47], s56 offen offset:0 sc1
    buffer_load_dwordx4 v[68:71], v4, s[44:47], s56 offen offset:1024 sc1
    buffer_load_dwordx4 v[72:75], v4, s[44:47], s56 offen offset:2048 sc1
    buffer_load_dwordx4 v[76:79], v4, s[44:47], s56 offen offset:3072 sc1
    buffer_load_dwordx4 v[80:83], v4, s[44:47], s57 offen offset:0 sc1
    buffer_load_dwordx4 v[84:87], v4, s[44:47], s57 offen offset:1024 sc1
    buffer_load_dwordx4 v[88:91], v4, s[44:47], s57 offen offset:2048 sc1
    buffer_load_dwordx4 v[92:95], v4, s[44:47], s57 offen offset:3072 sc1
    s_add_u32 s67, s67, 1
    v_mov_b32 v38, 0
    s_waitcnt vmcnt(7)
    v_xor_b32 v39, v66, v20
    v_xor_b32 v40, v67, v22
    v_or3_b32 v38, v38, v39, v40
    s_waitcnt vmcnt(6)
    v_xor_b32 v39, v70, v20
    v_xor_b32 v40, v71, v22
    v_or3_b32 v38, v38, v39, v40
    s_waitcnt vmcnt(5)
    v_xor_b32 v39, v74, v20
    v_xor_b32 v40, v75, v22
    v_or3_b32 v38, v38, v39, v40
    s_waitcnt vmcnt(4)
    v_xor_b32 v39, v78, v20
    v_xor_b32 v40, v79, v22
    v_or3_b32 v38, v38, v39, v40
    s_waitcnt vmcnt(3)
    v_xor_b32 v39, v82, v20
    v_xor_b32 v40, v83, v22
    v_or3_b32 v38, v38, v39, v40
    s_waitcnt vmcnt(2)
    v_xor_b32 v39, v86, v20
    v_xor_b32 v40, v87, v22
    v_or3_b32 v38, v38, v39, v40
    s_waitcnt vmcnt(1)
    v_xor_b32 v39, v90, v20
    v_xor_b32 v40, v91, v22
    v_or3_b32 v38, v38, v39, v40
    s_waitcnt vmcnt(0)
    v_xor_b32 v39, v94, v20
    v_xor_b32 v40, v95, v22
    v_or3_b32 v38, v38, v39, v40
    v_cmp_ne_u32 vcc, 0, v38
    s_nop 1
    s_cmp_eq_u64 vcc, 0
    s_cbranch_scc1 L_qp_ok
    s_cmp_lt_u32 s67, 8
    s_cbranch_scc1 L_qp
    s_cmp_eq_u32 s67, 8
    s_cbranch_scc0 L_qp_c
    v_mov_b32 v195, v21
    v_mov_b32 v203, v21
    v_mov_b32 v211, v21
    v_mov_b32 v219, v21
    buffer_store_dwordx4 v[192:195], v3, s[44:47], s66 offen offset:0 sc1
    buffer_store_dwordx4 v[200:203], v3, s[44:47], s66 offen offset:256 sc1
    buffer_store_dwordx4 v[208:211], v3, s[44:47], s66 offen offset:512 sc1
    buffer_store_dwordx4 v[216:219], v3, s[44:47], s66 offen offset:768 sc1
L_qp_c:
    s_xor_b32 s56, s56, 0x300000
    s_xor_b32 s57, s57, 0x300000
    v_xor_b32 v22, s59, v22
    s_cmp_lt_u32 s67, 200000
    s_cbranch_scc1 L_qp
L_qp_ok:
    v_pk_add_f32 v[64:65], v[64:65], v[80:81]
    v_pk_add_f32 v[68:69], v[68:69], v[84:85]
    v_pk_add_f32 v[72:73], v[72:73], v[88:89]
    v_pk_add_f32 v[76:77], v[76:77], v[92:93]
    v_pk_add_f32 v[64:65], v[64:65], v[72:73]
    v_pk_add_f32 v[68:69], v[68:69], v[76:77]
    v_pk_add_f32 v[64:65], v[64:65], v[68:69]
    v_cvt_pk_bf16_f32 v38, v64, v65
    v_lshlrev_b32 v39, 2, v5
    v_lshl_add_u32 v39, v6, 4, v39
    ds_write_b32 v39, v38 offset:0
    s_bfe_u32 s58, s56, 65556
    v_mov_b32 v40, s58
    ds_write_b32 v60, v40 offset:264
    s_cmp_eq_u32 s34, 0
    s_cbranch_scc0 L_qnl
    v_lshlrev_b32 v38, 3, v1
    s_mov_b64 exec, 0xffff
    buffer_store_dwordx2 v[20:21], v38, s[44:47], s61 offen
    s_mov_b64 exec, -1
L_qnl:
    s_waitcnt lgkmcnt(0)
    s_setprio 0
L_bar1:
    s_barrier
L_ab1:
    v_and_b32 v38, 1, v6
    v_lshlrev_b32 v38, 4, v38
    v_mov_b32 v39, 0xffff
    v_lshlrev_b32 v38, v38, v39
    v_bfe_u32 v39, v6, 1, 2
    v_cmp_eq_u32 vcc, 0, v39
    s_nop 1
    v_cndmask_b32 v8, 0, v38, vcc
    v_cmp_eq_u32 vcc, 1, v39
    s_nop 1
    v_cndmask_b32 v9, 0, v38, vcc
    v_cmp_eq_u32 vcc, 2, v39
    s_nop 1
    v_cndmask_b32 v10, 0, v38, vcc
    v_cmp_eq_u32 vcc, 3, v39
    s_nop 1
    v_cndmask_b32 v11, 0, v38, vcc
    v_mov_b32 v60, 0
    v_lshlrev_b32 v38, 5, v6
    v_lshl_add_u32 v58, v5, 4, v38
    s_lshl_b32 s69, s29, 5
    s_add_u32 s69, s69, s30
    s_lshl_b32 s69, s69, 1
    s_add_u32 s69, s69, s31
    s_lshl_b32 s69, s69, 10
    s_add_u32 s69, s69, 0x80000
    s_cmp_eq_u32 s33, 1
    s_cbranch_scc1 L_f1
    s_cmp_eq_u32 s33, 3
    s_cbranch_scc0 L_wo
    s_lshl_b32 s58, s29, 7
    s_add_u32 s58, s58, 0xc9000
    buffer_load_dwordx2 v[22:23], v60, s[44:47], s58 offen sc1
    s_branch L_wo
L_f1:
    s_cmp_lt_u32 s30, 28
    s_cbranch_scc0 L_f1x
    ds_read_b128 v[12:15], v4 offset:4096
    ds_read_b128 v[16:19], v4 offset:5120
    ds_read_b64 v[20:21], v60 offset:256
    ds_read_b32 v22, v60 offset:264
    s_mov_b32 s62, 0x05040100
    s_mov_b32 s63, 0x07060302
    s_waitcnt vmcnt(0) lgkmcnt(0)
    v_perm_b32 v48, v68, v64, s62
    v_perm_b32 v49, v76, v72, s62
    v_perm_b32 v50, v84, v80, s62
    v_perm_b32 v51, v92, v88, s62
    v_perm_b32 v52, v68, v64, s63
    v_perm_b32 v53, v76, v72, s63
    v_perm_b32 v54, v84, v80, s63
    v_perm_b32 v55, v92, v88, s63
    v_mfma_f32_16x16x32_bf16 v[192:195], v[12:15], v[48:51], 0
    v_perm_b32 v48, v69, v65, s62
    v_perm_b32 v49, v77, v73, s62
    v_perm_b32 v50, v85, v81, s62
    v_perm_b32 v51, v93, v89, s62
    v_mfma_f32_16x16x32_bf16 v[196:199], v[12:15], v[52:55], 0
    v_perm_b32 v52, v69, v65, s63
    v_perm_b32 v53, v77, v73, s63
    v_perm_b32 v54, v85, v81, s63
    v_perm_b32 v55, v93, v89, s63
    v_mfma_f32_16x16x32_bf16 v[200:203], v[12:15], v[48:51], 0
    v_perm_b32 v48, v70, v66, s62
    v_perm_b32 v49, v78, v74, s62
    v_perm_b32 v50, v86, v82, s62
    v_perm_b32 v51, v94, v90, s62
    v_mfma_f32_16x16x32_bf16 v[204:207], v[12:15], v[52:55], 0
    v_perm_b32 v52, v70, v66, s63
    v_perm_b32 v53, v78, v74, s63
    v_perm_b32 v54, v86, v82, s63
    v_perm_b32 v55, v94, v90, s63
    v_mfma_f32_16x16x32_bf16 v[208:211], v[12:15], v[48:51], 0
    v_perm_b32 v48, v71, v67, s62
    v_perm_b32 v49, v79, v75, s62
    v_perm_b32 v50, v87, v83, s62
    v_perm_b32 v51, v95, v91, s62
    v_mfma_f32_16x16x32_bf16 v[212:215], v[12:15], v[52:55], 0
    v_perm_b32 v52, v71, v67, s63
    v_perm_b32 v53, v79, v75, s63
    v_perm_b32 v54, v87, v83, s63
    v_perm_b32 v55, v95, v91, s63
    v_mfma_f32_16x16x32_bf16 v[216:219], v[12:15], v[48:51], 0
    v_perm_b32 v48, v100, v96, s62
    v_perm_b32 v49, v108, v104, s62
    v_perm_b32 v50, v116, v112, s62
    v_perm_b32 v51, v124, v120, s62
    v_mfma_f32_16x16x32_bf16 v[220:223], v[12:15], v[52:55], 0
    v_perm_b32 v52, v100, v96, s63
    v_perm_b32 v53, v108, v104, s63
    v_perm_b32 v54, v116, v112, s63
    v_perm_b32 v55, v124, v120, s63
    v_mfma_f32_16x16x32_bf16 v[192:195], v[16:19], v[48:51], v[192:195]
    v_perm_b32 v48, v101, v97, s62
    v_perm_b32 v49, v109, v105, s62
    v_perm_b32 v50, v117, v113, s62
    v_perm_b32 v51, v125, v121, s62
    v_mfma_f32_16x16x32_bf16 v[196:199], v[16:19], v[52:55], v[196:199]
    v_perm_b32 v52, v101, v97, s63
    v_perm_b32 v53, v109, v105, s63
    v_perm_b32 v54, v117, v113, s63
    v_perm_b32 v55, v125, v121, s63
    v_mfma_f32_16x16x32_bf16 v[200:203], v[16:19], v[48:51], v[200:203]
    v_perm_b32 v48, v102, v98, s62
    v_perm_b32 v49, v110, v106, s62
    v_perm_b32 v50, v118, v114, s62
    v_perm_b32 v51, v126, v122, s62
    v_mfma_f32_16x16x32_bf16 v[204:207], v[16:19], v[52:55], v[204:207]
    v_perm_b32 v52, v102, v98, s63
    v_perm_b32 v53, v110, v106, s63
    v_perm_b32 v54, v118, v114, s63
    v_perm_b32 v55, v126, v122, s63
    v_mfma_f32_16x16x32_bf16 v[208:211], v[16:19], v[48:51], v[208:211]
    v_perm_b32 v48, v103, v99, s62
    v_perm_b32 v49, v111, v107, s62
    v_perm_b32 v50, v119, v115, s62
    v_perm_b32 v51, v127, v123, s62
    v_mfma_f32_16x16x32_bf16 v[212:215], v[16:19], v[52:55], v[212:215]
    v_perm_b32 v52, v103, v99, s63
    v_perm_b32 v53, v111, v107, s63
    v_perm_b32 v54, v119, v115, s63
    v_perm_b32 v55, v127, v123, s63
    v_mfma_f32_16x16x32_bf16 v[216:219], v[16:19], v[48:51], v[216:219]
    s_nop 1
    v_mfma_f32_16x16x32_bf16 v[220:223], v[16:19], v[52:55], v[220:223]
    v_lshlrev_b32 v3, 13, v5
    v_lshl_add_u32 v3, v6, 4, v3
    s_lshl_b32 s56, s30, 15
    s_add_u32 s56, s56, 0x300000
    s_lshl_b32 s58, s34, 10
    s_add_u32 s58, s58, s56
    s_nop 4
    v_readfirstlane_b32 s35, v22
    v_mov_b32 v193, v196
    v_mov_b32 v194, v20
    v_mov_b32 v195, v21
    v_mov_b32 v201, v204
    v_mov_b32 v202, v20
    v_mov_b32 v203, v21
    v_mov_b32 v209, v212
    v_mov_b32 v210, v20
    v_mov_b32 v211, v21
    v_mov_b32 v217, v220
    v_mov_b32 v218, v20
    v_mov_b32 v219, v21
    s_cmp_eq_u32 s35, 1
    s_cbranch_scc1 L_f1p
    buffer_store_dwordx4 v[192:195], v3, s[44:47], s58 offen offset:0 sc1
    buffer_store_dwordx4 v[200:203], v3, s[44:47], s58 offen offset:256 sc1
    buffer_store_dwordx4 v[208:211], v3, s[44:47], s58 offen offset:512 sc1
    buffer_store_dwordx4 v[216:219], v3, s[44:47], s58 offen offset:768 sc1
    s_branch L_f1q
L_f1p:
    buffer_store_dwordx4 v[192:195], v3, s[44:47], s58 offen offset:0
    buffer_store_dwordx4 v[200:203], v3, s[44:47], s58 offen offset:256
    buffer_store_dwordx4 v[208:211], v3, s[44:47], s58 offen offset:512
    buffer_store_dwordx4 v[216:219], v3, s[44:47], s58 offen offset:768
L_f1q:
    s_waitcnt vmcnt(0)
    s_branch L_wo
L_f1x:
    v_mov_b32 v38, 320
    v_mov_b32 v39, 256
    s_mov_b64 exec, 1
    ds_add_u32 v38, v39
    s_mov_b64 exec, -1
L_wo:
    s_mov_b32 s40, s12
    s_mov_b32 s41, s13
    s_mov_b32 s42, 0x400000
    s_mov_b32 s43, 0x00020000
    v_lshlrev_b32 v38, 13, v5
    v_lshl_add_u32 v2, v6, 4, v38
    s_lshl_b32 s66, s30, 17
    s_lshl_b32 s58, s33, 8
    s_add_u32 s66, s66, s58
    s_cmp_eq_u32 s33, 2
    s_cbranch_scc1 L_woe
    s_add_u32 s58, s66, 0x0
    buffer_load_dwordx4 v[64:67], v2, s[40:43], s58 offen nt
    s_waitcnt vmcnt(0)
    s_add_u32 s58, s66, 0x400
    buffer_load_dwordx4 v[68:71], v2, s[40:43], s58 offen nt
    s_waitcnt vmcnt(0)
    s_add_u32 s58, s66, 0x800
    buffer_load_dwordx4 v[72:75], v2, s[40:43], s58 offen nt
    s_waitcnt vmcnt(0)
    s_add_u32 s58, s66, 0xc00
    buffer_load_dwordx4 v[76:79], v2, s[40:43], s58 offen nt
    s_waitcnt vmcnt(0)
    s_add_u32 s58, s66, 0x1000
    buffer_load_dwordx4 v[80:83], v2, s[40:43], s58 offen nt
    s_waitcnt vmcnt(0)
    s_add_u32 s58, s66, 0x1400
    buffer_load_dwordx4 v[84:87], v2, s[40:43], s58 offen nt
    s_waitcnt vmcnt(0)
    s_add_u32 s58, s66, 0x1800
    buffer_load_dwordx4 v[88:91], v2, s[40:43], s58 offen nt
    s_waitcnt vmcnt(0)
    s_add_u32 s58, s66, 0x1c00
    buffer_load_dwordx4 v[92:95], v2, s[40:43], s58 offen nt
    s_waitcnt vmcnt(0)
    s_add_u32 s58, s66, 0x8000
    buffer_load_dwordx4 v[96:99], v2, s[40:43], s58 offen nt
    s_waitcnt vmcnt(0)
    s_add_u32 s58, s66, 0x8400
    buffer_load_dwordx4 v[100:103], v2, s[40:43], s58 offen nt
    s_waitcnt vmcnt(0)
    s_add_u32 s58, s66, 0x8800
    buffer_load_dwordx4 v[104:107], v2, s[40:43], s58 offen nt
    s_waitcnt vmcnt(0)
    s_add_u32 s58, s66, 0x8c00
    buffer_load_dwordx4 v[108:111], v2, s[40:43], s58 offen nt
    s_waitcnt vmcnt(0)
    s_add_u32 s58, s66, 0x9000
    buffer_load_dwordx4 v[112:115], v2, s[40:43], s58 offen nt
    s_waitcnt vmcnt(0)
    s_add_u32 s58, s66, 0x9400
    buffer_load_dwordx4 v[116:119], v2, s[40:43], s58 offen nt
    s_waitcnt vmcnt(0)
    s_add_u32 s58, s66, 0x9800
    buffer_load_dwordx4 v[120:123], v2, s[40:43], s58 offen nt
    s_waitcnt vmcnt(0)
    s_add_u32 s58, s66, 0x9c00
    buffer_load_dwordx4 v[124:127], v2, s[40:43], s58 offen nt
    s_waitcnt vmcnt(0)
    s_add_u32 s58, s66, 0x10000
    buffer_load_dwordx4 v[128:131], v2, s[40:43], s58 offen nt
    s_waitcnt vmcnt(0)
    s_add_u32 s58, s66, 0x10400
    buffer_load_dwordx4 v[132:135], v2, s[40:43], s58 offen nt
    s_waitcnt vmcnt(0)
    s_add_u32 s58, s66, 0x10800
    buffer_load_dwordx4 v[136:139], v2, s[40:43], s58 offen nt
    s_waitcnt vmcnt(0)
    s_add_u32 s58, s66, 0x10c00
    buffer_load_dwordx4 v[140:143], v2, s[40:43], s58 offen nt
    s_waitcnt vmcnt(0)
    s_add_u32 s58, s66, 0x11000
    buffer_load_dwordx4 v[144:147], v2, s[40:43], s58 offen nt
    s_waitcnt vmcnt(0)
    s_add_u32 s58, s66, 0x11400
    buffer_load_dwordx4 v[148:151], v2, s[40:43], s58 offen nt
    s_waitcnt vmcnt(0)
    s_add_u32 s58, s66, 0x11800
    buffer_load_dwordx4 v[152:155], v2, s[40:43], s58 offen nt
    s_waitcnt vmcnt(0)
    s_add_u32 s58, s66, 0x11c00
    buffer_load_dwordx4 v[156:159], v2, s[40:43], s58 offen nt
    s_waitcnt vmcnt(0)
    s_add_u32 s58, s66, 0x18000
    buffer_load_dwordx4 v[160:163], v2, s[40:43], s58 offen nt
    s_waitcnt vmcnt(0)
    s_add_u32 s58, s66, 0x18400
    buffer_load_dwordx4 v[164:167], v2, s[40:43], s58 offen nt
    s_waitcnt vmcnt(0)
    s_add_u32 s58, s66, 0x18800
    buffer_load_dwordx4 v[168:171], v2, s[40:43], s58 offen nt
    s_waitcnt vmcnt(0)
    s_add_u32 s58, s66, 0x18c00
    buffer_load_dwordx4 v[172:175], v2, s[40:43], s58 offen nt
    s_waitcnt vmcnt(0)
    s_add_u32 s58, s66, 0x19000
    buffer_load_dwordx4 v[176:179], v2, s[40:43], s58 offen nt
    s_waitcnt vmcnt(0)
    s_add_u32 s58, s66, 0x19400
    buffer_load_dwordx4 v[180:183], v2, s[40:43], s58 offen nt
    s_waitcnt vmcnt(0)
    s_add_u32 s58, s66, 0x19800
    buffer_load_dwordx4 v[184:187], v2, s[40:43], s58 offen nt
    s_waitcnt vmcnt(0)
    s_add_u32 s58, s66, 0x19c00
    buffer_load_dwordx4 v[188:191], v2, s[40:43], s58 offen nt
L_woe:
    s_waitcnt vmcnt(0)
    v_lshrrev_b32 v38, 3, v1
    v_lshlrev_b32 v38, 11, v38
    v_and_b32 v39, 7, v1
    v_lshl_add_u32 v192, v39, 4, v38
    v_add_u32 v193, 0x4000, v192
    v_add_u32 v194, 0x8000, v192
    v_add_u32 v195, 0xc000, v192
    v_add_u32 v196, 0x10000, v192
    v_add_u32 v197, 0x14000, v192
    v_add_u32 v198, 0x18000, v192
    v_add_u32 v199, 0x1c000, v192
    v_lshlrev_b32 v59, 3, v39
    v_and_b32 v38, 1, v5
    v_lshl_add_u32 v59, v38, 2, v59
    v_and_b32 v38, 2, v5
    v_add_u32 v59, v59, v38
    s_cmp_eq_u32 s33, 3
    s_cbranch_scc1 L_w3
    s_cmp_eq_u32 s33, 2
    s_cbranch_scc0 L_nctl
    s_and_b32 s56, s2, 7
    s_lshl_b32 s56, s56, 8
    s_add_u32 s56, s56, 0xca000
    s_lshr_b32 s57, s2, 3
    s_lshl_b32 s57, s57, 2
    s_add_u32 s57, s57, s56
    v_lshlrev_b32 v3, 2, v1
    v_mov_b32 v7, 336
    v_and_b32 v63, 3, v1
    v_lshlrev_b32 v63, 2, v63
    s_mov_b32 s72, -1
    s_mov_b32 s73, 0
    s_mov_b32 s67, 0
L_ctl:
    s_cmp_ge_u32 s67, 16
    s_cbranch_scc1 L_ctl_r
    s_cmp_eq_u32 s67, 1
    s_cbranch_scc1 L_cw1
    s_cmp_eq_u32 s67, 2
    s_cbranch_scc1 L_cw2
    s_cmp_eq_u32 s67, 3
    s_cbranch_scc1 L_cw3
    s_cmp_eq_u32 s67, 4
    s_cbranch_scc1 L_cw4
    s_cmp_eq_u32 s67, 5
    s_cbranch_scc1 L_cw5
    s_cmp_eq_u32 s67, 6
    s_cbranch_scc1 L_cw6
    s_cmp_eq_u32 s67, 7
    s_cbranch_scc1 L_cw7
    s_cmp_eq_u32 s67, 8
    s_cbranch_scc1 L_cw8
    s_cmp_eq_u32 s67, 9
    s_cbranch_scc1 L_cw9
    s_cmp_eq_u32 s67, 10
    s_cbranch_scc1 L_cw10
    s_cmp_eq_u32 s67, 11
    s_cbranch_scc1 L_cw11
    s_cmp_eq_u32 s67, 12
    s_cbranch_scc1 L_cw12
    s_cmp_eq_u32 s67, 13
    s_cbranch_scc1 L_cw13
    s_cmp_eq_u32 s67, 14
    s_cbranch_scc1 L_cw14
    s_cmp_eq_u32 s67, 15
    s_cbranch_scc1 L_cw15
L_cw0:
    s_add_u32 s58, s66, 0x0
    buffer_load_dwordx4 v[64:67], v2, s[40:43], s58 offen nt
    s_add_u32 s58, s66, 0x400
    buffer_load_dwordx4 v[68:71], v2, s[40:43], s58 offen nt
    s_branch L_ctl_r
L_cw1:
    s_add_u32 s58, s66, 0x800
    buffer_load_dwordx4 v[72:75], v2, s[40:43], s58 offen nt
    s_add_u32 s58, s66, 0xc00
    buffer_load_dwordx4 v[76:79], v2, s[40:43], s58 offen nt
    s_branch L_ctl_r
L_cw2:
    s_add_u32 s58, s66, 0x1000
    buffer_load_dwordx4 v[80:83], v2, s[40:43], s58 offen nt
    s_add_u32 s58, s66, 0x1400
    buffer_load_dwordx4 v[84:87], v2, s[40:43], s58 offen nt
    s_branch L_ctl_r
L_cw3:
    s_add_u32 s58, s66, 0x1800
    buffer_load_dwordx4 v[88:91], v2, s[40:43], s58 offen nt
    s_add_u32 s58, s66, 0x1c00
    buffer_load_dwordx4 v[92:95], v2, s[40:43], s58 offen nt
    s_branch L_ctl_r
L_cw4:
    s_add_u32 s58, s66, 0x8000
    buffer_load_dwordx4 v[96:99], v2, s[40:43], s58 offen nt
    s_add_u32 s58, s66, 0x8400
    buffer_load_dwordx4 v[100:103], v2, s[40:43], s58 offen nt
    s_branch L_ctl_r
L_cw5:
    s_add_u32 s58, s66, 0x8800
    buffer_load_dwordx4 v[104:107], v2, s[40:43], s58 offen nt
    s_add_u32 s58, s66, 0x8c00
    buffer_load_dwordx4 v[108:111], v2, s[40:43], s58 offen nt
    s_branch L_ctl_r
L_cw6:
    s_add_u32 s58, s66, 0x9000
    buffer_load_dwordx4 v[112:115], v2, s[40:43], s58 offen nt
    s_add_u32 s58, s66, 0x9400
    buffer_load_dwordx4 v[116:119], v2, s[40:43], s58 offen nt
    s_branch L_ctl_r
L_cw7:
    s_add_u32 s58, s66, 0x9800
    buffer_load_dwordx4 v[120:123], v2, s[40:43], s58 offen nt
    s_add_u32 s58, s66, 0x9c00
    buffer_load_dwordx4 v[124:127], v2, s[40:43], s58 offen nt
    s_branch L_ctl_r
L_cw8:
    s_add_u32 s58, s66, 0x10000
    buffer_load_dwordx4 v[128:131], v2, s[40:43], s58 offen nt
    s_add_u32 s58, s66, 0x10400
    buffer_load_dwordx4 v[132:135], v2, s[40:43], s58 offen nt
    s_branch L_ctl_r
L_cw9:
    s_add_u32 s58, s66, 0x10800
    buffer_load_dwordx4 v[136:139], v2, s[40:43], s58 offen nt
    s_add_u32 s58, s66, 0x10c00
    buffer_load_dwordx4 v[140:143], v2, s[40:43], s58 offen nt
    s_branch L_ctl_r
L_cw10:
    s_add_u32 s58, s66, 0x11000
    buffer_load_dwordx4 v[144:147], v2, s[40:43], s58 offen nt
    s_add_u32 s58, s66, 0x11400
    buffer_load_dwordx4 v[148:151], v2, s[40:43], s58 offen nt
    s_branch L_ctl_r
L_cw11:
    s_add_u32 s58, s66, 0x11800
    buffer_load_dwordx4 v[152:155], v2, s[40:43], s58 offen nt
    s_add_u32 s58, s66, 0x11c00
    buffer_load_dwordx4 v[156:159], v2, s[40:43], s58 offen nt
    s_branch L_ctl_r
L_cw12:
    s_add_u32 s58, s66, 0x18000
    buffer_load_dwordx4 v[160:163], v2, s[40:43], s58 offen nt
    s_add_u32 s58, s66, 0x18400
    buffer_load_dwordx4 v[164:167], v2, s[40:43], s58 offen nt
    s_branch L_ctl_r
L_cw13:
    s_add_u32 s58, s66, 0x18800
    buffer_load_dwordx4 v[168:171], v2, s[40:43], s58 offen nt
    s_add_u32 s58, s66, 0x18c00
    buffer_load_dwordx4 v[172:175], v2, s[40:43], s58 offen nt
    s_branch L_ctl_r
L_cw14:
    s_add_u32 s58, s66, 0x19000
    buffer_load_dwordx4 v[176:179], v2, s[40:43], s58 offen nt
    s_add_u32 s58, s66, 0x19400
    buffer_load_dwordx4 v[180:183], v2, s[40:43], s58 offen nt
    s_branch L_ctl_r
L_cw15:
    s_add_u32 s58, s66, 0x19800
    buffer_load_dwordx4 v[184:187], v2, s[40:43], s58 offen nt
    s_add_u32 s58, s66, 0x19c00
    buffer_load_dwordx4 v[188:191], v2, s[40:43], s58 offen nt
L_ctl_r:
    ds_read_b128 v[12:15], v7
    s_waitcnt lgkmcnt(0)
    v_add3_u32 v12, v12, v13, v14
    v_add_u32 v12, v12, v15
    s_mov_b64 exec, 1
    buffer_store_dword v12, v60, s[44:47], s57 offen
    s_mov_b64 exec, -1
    s_mov_b32 exec_hi, 0
    buffer_load_dword v16, v3, s[44:47], s56 offen sc1
    s_mov_b64 exec, -1
    v_readfirstlane_b32 s74, v12
    s_add_u32 s67, s67, 1
    s_cmp_eq_u32 s72, -1
    s_cselect_b32 s72, s74, s72
    s_add_u32 s58, s74, s72
    s_mov_b32 s72, s74
    s_waitcnt vmcnt(0)
    v_lshlrev_b32 v17, 1, v16
    v_subrev_u32 v17, s58, v17
    v_add_u32 v18, 192, v17
    v_cmp_gt_u32 vcc, 384, v18
    s_nop 1
    s_mov_b32 vcc_hi, 0
    s_nop 1
    v_cndmask_b32 v17, 0, v17, vcc
    v_readlane_b32 s78, v16, 32
    s_nop 1
    v_add_u32_dpp v17, v17, v17 row_ror:8 row_mask:0xf bank_mask:0xf
    s_nop 1
    v_add_u32_dpp v17, v17, v17 row_ror:4 row_mask:0xf bank_mask:0xf
    s_nop 1
    v_add_u32_dpp v17, v17, v17 row_ror:2 row_mask:0xf bank_mask:0xf
    s_nop 1
    v_add_u32_dpp v17, v17, v17 row_ror:1 row_mask:0xf bank_mask:0xf
    s_nop 0
    v_readlane_b32 s62, v17, 0
    v_readlane_b32 s63, v17, 16
    s_add_u32 s60, s78, 6144
    s_cmp_lt_u32 s60, 12288
    s_cselect_b32 s78, s78, 0
    s_mov_b32 s78, 0
    s_add_u32 s62, s62, s63
    s_sub_u32 s78, s62, s78
    ds_read_b128 v[20:23], v7
    ds_read_b32 v18, v63 offset:336
    s_waitcnt lgkmcnt(0)
    v_add3_u32 v20, v20, v21, v22
    v_lshlrev_b32 v18, 2, v18
    v_add_u32 v20, v20, v23
    v_sub_u32 v18, v20, v18
    v_mul_i32_i24 v18, 64, v18
    v_add_u32 v18, s78, v18
    v_mov_b32 v19, 0
    v_cmp_le_i32 vcc, -372, v18
    s_nop 1
    v_addc_co_u32 v19, vcc, 0, v19, vcc
    v_cmp_le_i32 vcc, 372, v18
    s_nop 1
    v_addc_co_u32 v19, vcc, 0, v19, vcc
    v_cmp_le_i32 vcc, 930, v18
    s_nop 1
    v_addc_co_u32 v19, vcc, 0, v19, vcc
    ds_write_b32 v63, v19 offset:352
    s_cmp_ge_u32 s67, 200000
    s_cbranch_scc1 L_bar2
    s_cmp_lt_u32 s74, 832
    s_cbranch_scc1 L_ctl
    s_cmp_lt_u32 s67, 16
    s_cbranch_scc1 L_ctl
    s_branch L_bar2
L_nctl:
    s_cmp_eq_u32 s33, 1
    s_cbranch_scc0 L_bar2
    s_cmp_lt_u32 s30, 28
    s_cbranch_scc0 L_bar2
L_st2:
    s_lshl_b32 s56, s30, 15
    s_lshl_b32 s58, s29, 13
    s_add_u32 s56, s56, s58
    s_add_u32 s56, s56, 0x300000
    s_add_u32 s57, s56, 4096
    s_mov_b32 s67, 0
    s_cmp_eq_u32 s35, 1
    s_cbranch_scc0 L_fp
    buffer_load_dwordx4 v[224:227], v4, s[44:47], s56 offen offset:0 nt
    buffer_load_dwordx4 v[228:231], v4, s[44:47], s56 offen offset:1024 nt
    buffer_load_dwordx4 v[232:235], v4, s[44:47], s56 offen offset:2048 nt
    buffer_load_dwordx4 v[236:239], v4, s[44:47], s56 offen offset:3072 nt
    buffer_load_dwordx4 v[240:243], v4, s[44:47], s57 offen offset:0 nt
    buffer_load_dwordx4 v[244:247], v4, s[44:47], s57 offen offset:1024 nt
    buffer_load_dwordx4 v[248:251], v4, s[44:47], s57 offen offset:2048 nt
    buffer_load_dwordx4 v[252:255], v4, s[44:47], s57 offen offset:3072 nt
    s_add_u32 s67, s67, 1
    v_mov_b32 v38, 0
    s_waitcnt vmcnt(7)
    v_xor_b32 v39, v226, v20
    v_xor_b32 v40, v227, v21
    v_or3_b32 v38, v38, v39, v40
    s_waitcnt vmcnt(6)
    v_xor_b32 v39, v230, v20
    v_xor_b32 v40, v231, v21
    v_or3_b32 v38, v38, v39, v40
    s_waitcnt vmcnt(5)
    v_xor_b32 v39, v234, v20
    v_xor_b32 v40, v235, v21
    v_or3_b32 v38, v38, v39, v40
    s_waitcnt vmcnt(4)
    v_xor_b32 v39, v238, v20
    v_xor_b32 v40, v239, v21
    v_or3_b32 v38, v38, v39, v40
    s_waitcnt vmcnt(3)
    v_xor_b32 v39, v242, v20
    v_xor_b32 v40, v243, v21
    v_or3_b32 v38, v38, v39, v40
    s_waitcnt vmcnt(2)
    v_xor_b32 v39, v246, v20
    v_xor_b32 v40, v247, v21
    v_or3_b32 v38, v38, v39, v40
    s_waitcnt vmcnt(1)
    v_xor_b32 v39, v250, v20
    v_xor_b32 v40, v251, v21
    v_or3_b32 v38, v38, v39, v40
    s_waitcnt vmcnt(0)
    v_xor_b32 v39, v254, v20
    v_xor_b32 v40, v255, v21
    v_or3_b32 v38, v38, v39, v40
    v_cmp_ne_u32 vcc, 0, v38
    s_nop 1
    s_cmp_eq_u64 vcc, 0
    s_cbranch_scc1 L_fp_ok
L_fp:
    buffer_load_dwordx4 v[224:227], v4, s[44:47], s56 offen offset:0 sc1
    buffer_load_dwordx4 v[228:231], v4, s[44:47], s56 offen offset:1024 sc1
    buffer_load_dwordx4 v[232:235], v4, s[44:47], s56 offen offset:2048 sc1
    buffer_load_dwordx4 v[236:239], v4, s[44:47], s56 offen offset:3072 sc1
    buffer_load_dwordx4 v[240:243], v4, s[44:47], s57 offen offset:0 sc1
    buffer_load_dwordx4 v[244:247], v4, s[44:47], s57 offen offset:1024 sc1
    buffer_load_dwordx4 v[248:251], v4, s[44:47], s57 offen offset:2048 sc1
    buffer_load_dwordx4 v[252:255], v4, s[44:47], s57 offen offset:3072 sc1
    s_add_u32 s67, s67, 1
    v_mov_b32 v38, 0
    s_waitcnt vmcnt(7)
    v_xor_b32 v39, v226, v20
    v_xor_b32 v40, v227, v21
    v_or3_b32 v38, v38, v39, v40
    s_waitcnt vmcnt(6)
    v_xor_b32 v39, v230, v20
    v_xor_b32 v40, v231, v21
    v_or3_b32 v38, v38, v39, v40
    s_waitcnt vmcnt(5)
    v_xor_b32 v39, v234, v20
    v_xor_b32 v40, v235, v21
    v_or3_b32 v38, v38, v39, v40
    s_waitcnt vmcnt(4)
    v_xor_b32 v39, v238, v20
    v_xor_b32 v40, v239, v21
    v_or3_b32 v38, v38, v39, v40
    s_waitcnt vmcnt(3)
    v_xor_b32 v39, v242, v20
    v_xor_b32 v40, v243, v21
    v_or3_b32 v38, v38, v39, v40
    s_waitcnt vmcnt(2)
    v_xor_b32 v39, v246, v20
    v_xor_b32 v40, v247, v21
    v_or3_b32 v38, v38, v39, v40
    s_waitcnt vmcnt(1)
    v_xor_b32 v39, v250, v20
    v_xor_b32 v40, v251, v21
    v_or3_b32 v38, v38, v39, v40
    s_waitcnt vmcnt(0)
    v_xor_b32 v39, v254, v20
    v_xor_b32 v40, v255, v21
    v_or3_b32 v38, v38, v39, v40
    v_cmp_ne_u32 vcc, 0, v38
    s_nop 1
    s_cmp_eq_u64 vcc, 0
    s_cbranch_scc1 L_fp_ok
    s_sleep 16
    s_cmp_lt_u32 s67, 200000
    s_cbranch_scc1 L_fp
L_fp_ok:
    v_pk_add_f32 v[224:225], v[224:225], v[240:241]
    v_pk_add_f32 v[228:229], v[228:229], v[244:245]
    v_pk_add_f32 v[232:233], v[232:233], v[248:249]
    v_pk_add_f32 v[236:237], v[236:237], v[252:253]
    v_pk_add_f32 v[224:225], v[224:225], v[232:233]
    v_pk_add_f32 v[228:229], v[228:229], v[236:237]
    v_pk_add_f32 v[224:225], v[224:225], v[228:229]
    v_cvt_pk_bf16_f32 v38, v224, v224
    v_and_b32 v224, 0xffff0000, v38
    v_cvt_pk_bf16_f32 v38, v225, v225
    v_and_b32 v225, 0xffff0000, v38
    s_nop 1
    v_mov_b32_dpp v12, v224 row_ror:8 row_mask:0xf bank_mask:0xf
    v_mov_b32_dpp v13, v225 row_ror:8 row_mask:0xf bank_mask:0xf
    v_mul_f32 v38, 0xbfb8aa3b, v224
    v_exp_f32 v38, v38
    s_nop 0
    v_add_f32 v38, 1.0, v38
    v_rcp_f32 v38, v38
    s_nop 0
    v_mul_f32 v224, v224, v38
    v_cvt_pk_bf16_f32 v38, v224, v224
    v_and_b32 v224, 0xffff0000, v38
    v_mul_f32 v224, v224, v12
    v_cvt_pk_bf16_f32 v56, v224, v224
    v_mul_f32 v38, 0xbfb8aa3b, v225
    v_exp_f32 v38, v38
    s_nop 0
    v_add_f32 v38, 1.0, v38
    v_rcp_f32 v38, v38
    s_nop 0
    v_mul_f32 v225, v225, v38
    v_cvt_pk_bf16_f32 v38, v225, v225
    v_and_b32 v225, 0xffff0000, v38
    v_mul_f32 v225, v225, v13
    v_cvt_pk_bf16_f32 v57, v225, v225
    s_mov_b32 s36, s20
    s_mov_b32 s37, s21
    s_mov_b32 s38, 0x1c0000
    s_mov_b32 s39, 0x00020000
    v_lshlrev_b32 v38, 11, v5
    v_lshl_add_u32 v2, v6, 4, v38
    s_lshl_b32 s66, s30, 16
    s_lshl_b32 s58, s31, 9
    s_add_u32 s66, s66, s58
    s_add_u32 s58, s66, 0x0
    buffer_load_dwordx4 v[224:227], v2, s[36:39], s58 offen nt
    s_add_u32 s58, s66, 0x2000
    buffer_load_dwordx4 v[228:231], v2, s[36:39], s58 offen nt
    s_add_u32 s58, s66, 0x4000
    buffer_load_dwordx4 v[232:235], v2, s[36:39], s58 offen nt
    s_add_u32 s58, s66, 0x6000
    buffer_load_dwordx4 v[236:239], v2, s[36:39], s58 offen nt
    v_and_b32_dpp v48, v56, v8 row_newbcast:0 row_mask:0xf bank_mask:0xf
    v_and_b32_dpp v49, v56, v9 row_newbcast:0 row_mask:0xf bank_mask:0xf
    v_and_b32_dpp v50, v56, v10 row_newbcast:0 row_mask:0xf bank_mask:0xf
    v_and_b32_dpp v51, v56, v11 row_newbcast:0 row_mask:0xf bank_mask:0xf
    v_and_b32_dpp v52, v56, v8 row_newbcast:1 row_mask:0xf bank_mask:0xf
    v_and_b32_dpp v53, v56, v9 row_newbcast:1 row_mask:0xf bank_mask:0xf
    v_and_b32_dpp v54, v56, v10 row_newbcast:1 row_mask:0xf bank_mask:0xf
    v_and_b32_dpp v55, v56, v11 row_newbcast:1 row_mask:0xf bank_mask:0xf
    s_waitcnt vmcnt(3)
    v_mfma_f32_16x16x32_bf16 v[28:31], v[48:51], v[224:227], 0
    s_add_u32 s58, s66, 0x8000
    buffer_load_dwordx4 v[240:243], v2, s[36:39], s58 offen nt
    v_and_b32_dpp v48, v56, v8 row_newbcast:2 row_mask:0xf bank_mask:0xf
    v_and_b32_dpp v49, v56, v9 row_newbcast:2 row_mask:0xf bank_mask:0xf
    v_and_b32_dpp v50, v56, v10 row_newbcast:2 row_mask:0xf bank_mask:0xf
    v_and_b32_dpp v51, v56, v11 row_newbcast:2 row_mask:0xf bank_mask:0xf
    s_waitcnt vmcnt(3)
    v_mfma_f32_16x16x32_bf16 v[28:31], v[52:55], v[228:231], v[28:31]
    s_add_u32 s58, s66, 0xa000
    buffer_load_dwordx4 v[244:247], v2, s[36:39], s58 offen nt
    v_and_b32_dpp v52, v56, v8 row_newbcast:3 row_mask:0xf bank_mask:0xf
    v_and_b32_dpp v53, v56, v9 row_newbcast:3 row_mask:0xf bank_mask:0xf
    v_and_b32_dpp v54, v56, v10 row_newbcast:3 row_mask:0xf bank_mask:0xf
    v_and_b32_dpp v55, v56, v11 row_newbcast:3 row_mask:0xf bank_mask:0xf
    s_waitcnt vmcnt(3)
    v_mfma_f32_16x16x32_bf16 v[28:31], v[48:51], v[232:235], v[28:31]
    s_add_u32 s58, s66, 0xc000
    buffer_load_dwordx4 v[248:251], v2, s[36:39], s58 offen nt
    v_and_b32_dpp v48, v56, v8 row_newbcast:4 row_mask:0xf bank_mask:0xf
    v_and_b32_dpp v49, v56, v9 row_newbcast:4 row_mask:0xf bank_mask:0xf
    v_and_b32_dpp v50, v56, v10 row_newbcast:4 row_mask:0xf bank_mask:0xf
    v_and_b32_dpp v51, v56, v11 row_newbcast:4 row_mask:0xf bank_mask:0xf
    s_waitcnt vmcnt(3)
    v_mfma_f32_16x16x32_bf16 v[28:31], v[52:55], v[236:239], v[28:31]
    s_add_u32 s58, s66, 0xe000
    buffer_load_dwordx4 v[252:255], v2, s[36:39], s58 offen nt
    v_and_b32_dpp v52, v56, v8 row_newbcast:5 row_mask:0xf bank_mask:0xf
    v_and_b32_dpp v53, v56, v9 row_newbcast:5 row_mask:0xf bank_mask:0xf
    v_and_b32_dpp v54, v56, v10 row_newbcast:5 row_mask:0xf bank_mask:0xf
    v_and_b32_dpp v55, v56, v11 row_newbcast:5 row_mask:0xf bank_mask:0xf
    s_waitcnt vmcnt(3)
    v_mfma_f32_16x16x32_bf16 v[28:31], v[48:51], v[240:243], v[28:31]
    s_add_u32 s58, s66, 0x400
    buffer_load_dwordx4 v[224:227], v2, s[36:39], s58 offen nt
    v_and_b32_dpp v48, v56, v8 row_newbcast:6 row_mask:0xf bank_mask:0xf
    v_and_b32_dpp v49, v56, v9 row_newbcast:6 row_mask:0xf bank_mask:0xf
    v_and_b32_dpp v50, v56, v10 row_newbcast:6 row_mask:0xf bank_mask:0xf
    v_and_b32_dpp v51, v56, v11 row_newbcast:6 row_mask:0xf bank_mask:0xf
    s_waitcnt vmcnt(3)
    v_mfma_f32_16x16x32_bf16 v[28:31], v[52:55], v[244:247], v[28:31]
    s_add_u32 s58, s66, 0x2400
    buffer_load_dwordx4 v[228:231], v2, s[36:39], s58 offen nt
    v_and_b32_dpp v52, v56, v8 row_newbcast:7 row_mask:0xf bank_mask:0xf
    v_and_b32_dpp v53, v56, v9 row_newbcast:7 row_mask:0xf bank_mask:0xf
    v_and_b32_dpp v54, v56, v10 row_newbcast:7 row_mask:0xf bank_mask:0xf
    v_and_b32_dpp v55, v56, v11 row_newbcast:7 row_mask:0xf bank_mask:0xf
    s_waitcnt vmcnt(3)
    v_mfma_f32_16x16x32_bf16 v[28:31], v[48:51], v[248:251], v[28:31]
    s_add_u32 s58, s66, 0x4400
    buffer_load_dwordx4 v[232:235], v2, s[36:39], s58 offen nt
    v_and_b32_dpp v48, v57, v8 row_newbcast:0 row_mask:0xf bank_mask:0xf
    v_and_b32_dpp v49, v57, v9 row_newbcast:0 row_mask:0xf bank_mask:0xf
    v_and_b32_dpp v50, v57, v10 row_newbcast:0 row_mask:0xf bank_mask:0xf
    v_and_b32_dpp v51, v57, v11 row_newbcast:0 row_mask:0xf bank_mask:0xf
    s_waitcnt vmcnt(3)
    v_mfma_f32_16x16x32_bf16 v[28:31], v[52:55], v[252:255], v[28:31]
    s_add_u32 s58, s66, 0x6400
    buffer_load_dwordx4 v[236:239], v2, s[36:39], s58 offen nt
    v_and_b32_dpp v52, v57, v8 row_newbcast:1 row_mask:0xf bank_mask:0xf
    v_and_b32_dpp v53, v57, v9 row_newbcast:1 row_mask:0xf bank_mask:0xf
    v_and_b32_dpp v54, v57, v10 row_newbcast:1 row_mask:0xf bank_mask:0xf
    v_and_b32_dpp v55, v57, v11 row_newbcast:1 row_mask:0xf bank_mask:0xf
    s_waitcnt vmcnt(3)
    v_mfma_f32_16x16x32_bf16 v[28:31], v[48:51], v[224:227], v[28:31]
    s_add_u32 s58, s66, 0x8400
    buffer_load_dwordx4 v[240:243], v2, s[36:39], s58 offen nt
    v_and_b32_dpp v48, v57, v8 row_newbcast:2 row_mask:0xf bank_mask:0xf
    v_and_b32_dpp v49, v57, v9 row_newbcast:2 row_mask:0xf bank_mask:0xf
    v_and_b32_dpp v50, v57, v10 row_newbcast:2 row_mask:0xf bank_mask:0xf
    v_and_b32_dpp v51, v57, v11 row_newbcast:2 row_mask:0xf bank_mask:0xf
    s_waitcnt vmcnt(3)
    v_mfma_f32_16x16x32_bf16 v[28:31], v[52:55], v[228:231], v[28:31]
    s_add_u32 s58, s66, 0xa400
    buffer_load_dwordx4 v[244:247], v2, s[36:39], s58 offen nt
    v_and_b32_dpp v52, v57, v8 row_newbcast:3 row_mask:0xf bank_mask:0xf
    v_and_b32_dpp v53, v57, v9 row_newbcast:3 row_mask:0xf bank_mask:0xf
    v_and_b32_dpp v54, v57, v10 row_newbcast:3 row_mask:0xf bank_mask:0xf
    v_and_b32_dpp v55, v57, v11 row_newbcast:3 row_mask:0xf bank_mask:0xf
    s_waitcnt vmcnt(3)
    v_mfma_f32_16x16x32_bf16 v[28:31], v[48:51], v[232:235], v[28:31]
    s_add_u32 s58, s66, 0xc400
    buffer_load_dwordx4 v[248:251], v2, s[36:39], s58 offen nt
    v_and_b32_dpp v48, v57, v8 row_newbcast:4 row_mask:0xf bank_mask:0xf
    v_and_b32_dpp v49, v57, v9 row_newbcast:4 row_mask:0xf bank_mask:0xf
    v_and_b32_dpp v50, v57, v10 row_newbcast:4 row_mask:0xf bank_mask:0xf
    v_and_b32_dpp v51, v57, v11 row_newbcast:4 row_mask:0xf bank_mask:0xf
    s_waitcnt vmcnt(3)
    v_mfma_f32_16x16x32_bf16 v[28:31], v[52:55], v[236:239], v[28:31]
    s_add_u32 s58, s66, 0xe400
    buffer_load_dwordx4 v[252:255], v2, s[36:39], s58 offen nt
    v_and_b32_dpp v52, v57, v8 row_newbcast:5 row_mask:0xf bank_mask:0xf
    v_and_b32_dpp v53, v57, v9 row_newbcast:5 row_mask:0xf bank_mask:0xf
    v_and_b32_dpp v54, v57, v10 row_newbcast:5 row_mask:0xf bank_mask:0xf
    v_and_b32_dpp v55, v57, v11 row_newbcast:5 row_mask:0xf bank_mask:0xf
    s_waitcnt vmcnt(3)
    v_mfma_f32_16x16x32_bf16 v[28:31], v[48:51], v[240:243], v[28:31]
    v_and_b32_dpp v48, v57, v8 row_newbcast:6 row_mask:0xf bank_mask:0xf
    v_and_b32_dpp v49, v57, v9 row_newbcast:6 row_mask:0xf bank_mask:0xf
    v_and_b32_dpp v50, v57, v10 row_newbcast:6 row_mask:0xf bank_mask:0xf
    v_and_b32_dpp v51, v57, v11 row_newbcast:6 row_mask:0xf bank_mask:0xf
    s_waitcnt vmcnt(2)
    v_mfma_f32_16x16x32_bf16 v[28:31], v[52:55], v[244:247], v[28:31]
    v_and_b32_dpp v52, v57, v8 row_newbcast:7 row_mask:0xf bank_mask:0xf
    v_and_b32_dpp v53, v57, v9 row_newbcast:7 row_mask:0xf bank_mask:0xf
    v_and_b32_dpp v54, v57, v10 row_newbcast:7 row_mask:0xf bank_mask:0xf
    v_and_b32_dpp v55, v57, v11 row_newbcast:7 row_mask:0xf bank_mask:0xf
    s_waitcnt vmcnt(1)
    v_mfma_f32_16x16x32_bf16 v[28:31], v[48:51], v[248:251], v[28:31]
    s_nop 1
    s_waitcnt vmcnt(0)
    v_mfma_f32_16x16x32_bf16 v[28:31], v[52:55], v[252:255], v[28:31]
    s_nop 7
    v_mov_b32 v32, v28
    v_mov_b32 v33, v29
    v_mov_b32 v34, v30
    v_mov_b32 v35, v31
    s_add_u32 s58, s66, 0x100
    buffer_load_dwordx4 v[224:227], v2, s[36:39], s58 offen nt
    s_add_u32 s58, s66, 0x2100
    buffer_load_dwordx4 v[228:231], v2, s[36:39], s58 offen nt
    s_add_u32 s58, s66, 0x4100
    buffer_load_dwordx4 v[232:235], v2, s[36:39], s58 offen nt
    s_add_u32 s58, s66, 0x6100
    buffer_load_dwordx4 v[236:239], v2, s[36:39], s58 offen nt
    v_and_b32_dpp v48, v56, v8 row_newbcast:0 row_mask:0xf bank_mask:0xf
    v_and_b32_dpp v49, v56, v9 row_newbcast:0 row_mask:0xf bank_mask:0xf
    v_and_b32_dpp v50, v56, v10 row_newbcast:0 row_mask:0xf bank_mask:0xf
    v_and_b32_dpp v51, v56, v11 row_newbcast:0 row_mask:0xf bank_mask:0xf
    v_and_b32_dpp v52, v56, v8 row_newbcast:1 row_mask:0xf bank_mask:0xf
    v_and_b32_dpp v53, v56, v9 row_newbcast:1 row_mask:0xf bank_mask:0xf
    v_and_b32_dpp v54, v56, v10 row_newbcast:1 row_mask:0xf bank_mask:0xf
    v_and_b32_dpp v55, v56, v11 row_newbcast:1 row_mask:0xf bank_mask:0xf
    s_waitcnt vmcnt(3)
    v_mfma_f32_16x16x32_bf16 v[28:31], v[48:51], v[224:227], 0
    s_add_u32 s58, s66, 0x8100
    buffer_load_dwordx4 v[240:243], v2, s[36:39], s58 offen nt
    v_and_b32_dpp v48, v56, v8 row_newbcast:2 row_mask:0xf bank_mask:0xf
    v_and_b32_dpp v49, v56, v9 row_newbcast:2 row_mask:0xf bank_mask:0xf
    v_and_b32_dpp v50, v56, v10 row_newbcast:2 row_mask:0xf bank_mask:0xf
    v_and_b32_dpp v51, v56, v11 row_newbcast:2 row_mask:0xf bank_mask:0xf
    s_waitcnt vmcnt(3)
    v_mfma_f32_16x16x32_bf16 v[28:31], v[52:55], v[228:231], v[28:31]
    s_add_u32 s58, s66, 0xa100
    buffer_load_dwordx4 v[244:247], v2, s[36:39], s58 offen nt
    v_and_b32_dpp v52, v56, v8 row_newbcast:3 row_mask:0xf bank_mask:0xf
    v_and_b32_dpp v53, v56, v9 row_newbcast:3 row_mask:0xf bank_mask:0xf
    v_and_b32_dpp v54, v56, v10 row_newbcast:3 row_mask:0xf bank_mask:0xf
    v_and_b32_dpp v55, v56, v11 row_newbcast:3 row_mask:0xf bank_mask:0xf
    s_waitcnt vmcnt(3)
    v_mfma_f32_16x16x32_bf16 v[28:31], v[48:51], v[232:235], v[28:31]
    s_add_u32 s58, s66, 0xc100
    buffer_load_dwordx4 v[248:251], v2, s[36:39], s58 offen nt
    v_and_b32_dpp v48, v56, v8 row_newbcast:4 row_mask:0xf bank_mask:0xf
    v_and_b32_dpp v49, v56, v9 row_newbcast:4 row_mask:0xf bank_mask:0xf
    v_and_b32_dpp v50, v56, v10 row_newbcast:4 row_mask:0xf bank_mask:0xf
    v_and_b32_dpp v51, v56, v11 row_newbcast:4 row_mask:0xf bank_mask:0xf
    s_waitcnt vmcnt(3)
    v_mfma_f32_16x16x32_bf16 v[28:31], v[52:55], v[236:239], v[28:31]
    s_add_u32 s58, s66, 0xe100
    buffer_load_dwordx4 v[252:255], v2, s[36:39], s58 offen nt
    v_and_b32_dpp v52, v56, v8 row_newbcast:5 row_mask:0xf bank_mask:0xf
    v_and_b32_dpp v53, v56, v9 row_newbcast:5 row_mask:0xf bank_mask:0xf
    v_and_b32_dpp v54, v56, v10 row_newbcast:5 row_mask:0xf bank_mask:0xf
    v_and_b32_dpp v55, v56, v11 row_newbcast:5 row_mask:0xf bank_mask:0xf
    s_waitcnt vmcnt(3)
    v_mfma_f32_16x16x32_bf16 v[28:31], v[48:51], v[240:243], v[28:31]
    s_add_u32 s58, s66, 0x500
    buffer_load_dwordx4 v[224:227], v2, s[36:39], s58 offen nt
    v_and_b32_dpp v48, v56, v8 row_newbcast:6 row_mask:0xf bank_mask:0xf
    v_and_b32_dpp v49, v56, v9 row_newbcast:6 row_mask:0xf bank_mask:0xf
    v_and_b32_dpp v50, v56, v10 row_newbcast:6 row_mask:0xf bank_mask:0xf
    v_and_b32_dpp v51, v56, v11 row_newbcast:6 row_mask:0xf bank_mask:0xf
    s_waitcnt vmcnt(3)
    v_mfma_f32_16x16x32_bf16 v[28:31], v[52:55], v[244:247], v[28:31]
    s_add_u32 s58, s66, 0x2500
    buffer_load_dwordx4 v[228:231], v2, s[36:39], s58 offen nt
    v_and_b32_dpp v52, v56, v8 row_newbcast:7 row_mask:0xf bank_mask:0xf
    v_and_b32_dpp v53, v56, v9 row_newbcast:7 row_mask:0xf bank_mask:0xf
    v_and_b32_dpp v54, v56, v10 row_newbcast:7 row_mask:0xf bank_mask:0xf
    v_and_b32_dpp v55, v56, v11 row_newbcast:7 row_mask:0xf bank_mask:0xf
    s_waitcnt vmcnt(3)
    v_mfma_f32_16x16x32_bf16 v[28:31], v[48:51], v[248:251], v[28:31]
    s_add_u32 s58, s66, 0x4500
    buffer_load_dwordx4 v[232:235], v2, s[36:39], s58 offen nt
    v_and_b32_dpp v48, v57, v8 row_newbcast:0 row_mask:0xf bank_mask:0xf
    v_and_b32_dpp v49, v57, v9 row_newbcast:0 row_mask:0xf bank_mask:0xf
    v_and_b32_dpp v50, v57, v10 row_newbcast:0 row_mask:0xf bank_mask:0xf
    v_and_b32_dpp v51, v57, v11 row_newbcast:0 row_mask:0xf bank_mask:0xf
    s_waitcnt vmcnt(3)
    v_mfma_f32_16x16x32_bf16 v[28:31], v[52:55], v[252:255], v[28:31]
    s_add_u32 s58, s66, 0x6500
    buffer_load_dwordx4 v[236:239], v2, s[36:39], s58 offen nt
    v_and_b32_dpp v52, v57, v8 row_newbcast:1 row_mask:0xf bank_mask:0xf
    v_and_b32_dpp v53, v57, v9 row_newbcast:1 row_mask:0xf bank_mask:0xf
    v_and_b32_dpp v54, v57, v10 row_newbcast:1 row_mask:0xf bank_mask:0xf
    v_and_b32_dpp v55, v57, v11 row_newbcast:1 row_mask:0xf bank_mask:0xf
    s_waitcnt vmcnt(3)
    v_mfma_f32_16x16x32_bf16 v[28:31], v[48:51], v[224:227], v[28:31]
    s_add_u32 s58, s66, 0x8500
    buffer_load_dwordx4 v[240:243], v2, s[36:39], s58 offen nt
    v_and_b32_dpp v48, v57, v8 row_newbcast:2 row_mask:0xf bank_mask:0xf
    v_and_b32_dpp v49, v57, v9 row_newbcast:2 row_mask:0xf bank_mask:0xf
    v_and_b32_dpp v50, v57, v10 row_newbcast:2 row_mask:0xf bank_mask:0xf
    v_and_b32_dpp v51, v57, v11 row_newbcast:2 row_mask:0xf bank_mask:0xf
    s_waitcnt vmcnt(3)
    v_mfma_f32_16x16x32_bf16 v[28:31], v[52:55], v[228:231], v[28:31]
    s_add_u32 s58, s66, 0xa500
    buffer_load_dwordx4 v[244:247], v2, s[36:39], s58 offen nt
    v_and_b32_dpp v52, v57, v8 row_newbcast:3 row_mask:0xf bank_mask:0xf
    v_and_b32_dpp v53, v57, v9 row_newbcast:3 row_mask:0xf bank_mask:0xf
    v_and_b32_dpp v54, v57, v10 row_newbcast:3 row_mask:0xf bank_mask:0xf
    v_and_b32_dpp v55, v57, v11 row_newbcast:3 row_mask:0xf bank_mask:0xf
    s_waitcnt vmcnt(3)
    v_mfma_f32_16x16x32_bf16 v[28:31], v[48:51], v[232:235], v[28:31]
    s_add_u32 s58, s66, 0xc500
    buffer_load_dwordx4 v[248:251], v2, s[36:39], s58 offen nt
    v_and_b32_dpp v48, v57, v8 row_newbcast:4 row_mask:0xf bank_mask:0xf
    v_and_b32_dpp v49, v57, v9 row_newbcast:4 row_mask:0xf bank_mask:0xf
    v_and_b32_dpp v50, v57, v10 row_newbcast:4 row_mask:0xf bank_mask:0xf
    v_and_b32_dpp v51, v57, v11 row_newbcast:4 row_mask:0xf bank_mask:0xf
    s_waitcnt vmcnt(3)
    v_mfma_f32_16x16x32_bf16 v[28:31], v[52:55], v[236:239], v[28:31]
    s_add_u32 s58, s66, 0xe500
    buffer_load_dwordx4 v[252:255], v2, s[36:39], s58 offen nt
    v_and_b32_dpp v52, v57, v8 row_newbcast:5 row_mask:0xf bank_mask:0xf
    v_and_b32_dpp v53, v57, v9 row_newbcast:5 row_mask:0xf bank_mask:0xf
    v_and_b32_dpp v54, v57, v10 row_newbcast:5 row_mask:0xf bank_mask:0xf
    v_and_b32_dpp v55, v57, v11 row_newbcast:5 row_mask:0xf bank_mask:0xf
    s_waitcnt vmcnt(3)
    v_mfma_f32_16x16x32_bf16 v[28:31], v[48:51], v[240:243], v[28:31]
    v_and_b32_dpp v48, v57, v8 row_newbcast:6 row_mask:0xf bank_mask:0xf
    v_and_b32_dpp v49, v57, v9 row_newbcast:6 row_mask:0xf bank_mask:0xf
    v_and_b32_dpp v50, v57, v10 row_newbcast:6 row_mask:0xf bank_mask:0xf
    v_and_b32_dpp v51, v57, v11 row_newbcast:6 row_mask:0xf bank_mask:0xf
    s_waitcnt vmcnt(2)
    v_mfma_f32_16x16x32_bf16 v[28:31], v[52:55], v[244:247], v[28:31]
    v_and_b32_dpp v52, v57, v8 row_newbcast:7 row_mask:0xf bank_mask:0xf
    v_and_b32_dpp v53, v57, v9 row_newbcast:7 row_mask:0xf bank_mask:0xf
    v_and_b32_dpp v54, v57, v10 row_newbcast:7 row_mask:0xf bank_mask:0xf
    v_and_b32_dpp v55, v57, v11 row_newbcast:7 row_mask:0xf bank_mask:0xf
    s_waitcnt vmcnt(1)
    v_mfma_f32_16x16x32_bf16 v[28:31], v[48:51], v[248:251], v[28:31]
    s_nop 1
    s_waitcnt vmcnt(0)
    v_mfma_f32_16x16x32_bf16 v[28:31], v[52:55], v[252:255], v[28:31]
    s_nop 7
    v_mov_b32 v38, 320
    s_mov_b32 s67, 0
L_lw1:
    ds_read_b32 v39, v38
    s_waitcnt lgkmcnt(0)
    v_readfirstlane_b32 s58, v39
    s_add_u32 s67, s67, 1
    s_and_b32 s58, s58, 0xf
    s_cmp_eq_u32 s58, 0x4
    s_cbranch_scc1 L_lw1_ok
    s_sleep 16
    s_cmp_lt_u32 s67, 200000
    s_cbranch_scc1 L_lw1
L_lw1_ok:
    s_mov_b32 exec_hi, 0
    buffer_store_dwordx4 v[32:35], v58, s[44:47], s69 offen sc1
    buffer_store_dwordx4 v[28:31], v58, s[44:47], s69 offen offset:512 sc1
    s_mov_b64 exec, -1
    s_waitcnt vmcnt(0)
    v_mov_b32 v38, 320
    v_mov_b32 v39, 256
    s_mov_b64 exec, 1
    ds_add_u32 v38, v39
    s_mov_b64 exec, -1
    s_branch L_bar2
L_w3:
    v_mov_b32 v38, 0x9e3779b9
    v_add_co_u32 v22, vcc, 0x7f4a7c15, v22
    s_nop 1
    v_addc_co_u32 v23, vcc, v38, v23, vcc
    v_mov_b32 v38, 320
    s_mov_b32 s67, 0
L_lw2:
    ds_read_b32 v39, v38
    s_waitcnt lgkmcnt(0)
    v_readfirstlane_b32 s58, v39
    s_add_u32 s67, s67, 1
    s_and_b32 s58, s58, 0xf
    s_cmp_eq_u32 s58, 0x4
    s_cbranch_scc1 L_lw2_ok
    s_sleep 16
    s_cmp_lt_u32 s67, 200000
    s_cbranch_scc1 L_lw2
L_lw2_ok:
    v_mov_b32 v28, -1
    v_mov_b32 v29, -1
    v_mov_b32 v30, -1
    v_mov_b32 v31, -1
    s_lshl_b32 s58, s2, 11
    buffer_store_dwordx4 v[28:31], v4, s[44:47], s58 offen sc1
    buffer_store_dwordx4 v[28:31], v4, s[44:47], s58 offen offset:1024 sc1
    s_waitcnt vmcnt(0)
    v_mov_b32 v38, 320
    s_mov_b32 s67, 0
L_lw3:
    ds_read_b32 v39, v38
    s_waitcnt lgkmcnt(0)
    v_readfirstlane_b32 s58, v39
    s_add_u32 s67, s67, 1
    s_and_b32 s58, s58, 0x10f
    s_cmp_eq_u32 s58, 0x104
    s_cbranch_scc1 L_lw3_ok
    s_sleep 16
    s_cmp_lt_u32 s67, 200000
    s_cbranch_scc1 L_lw3
L_lw3_ok:
    v_mov_b32 v38, 272
    ds_read_b128 v[12:15], v38
    ds_read_b128 v[16:19], v38 offset:16
    s_waitcnt lgkmcnt(0)
    v_max_f32 v20, v12, v14
    v_max3_f32 v20, v20, v16, v18
    v_mov_b32 v21, 0
    s_mov_b32 s60, 0x3fb8aa3b
    v_sub_f32 v38, v12, v20
    v_mul_f32 v38, s60, v38
    v_exp_f32 v38, v38
    s_nop 0
    v_fmac_f32 v21, v38, v13
    v_sub_f32 v38, v14, v20
    v_mul_f32 v38, s60, v38
    v_exp_f32 v38, v38
    s_nop 0
    v_fmac_f32 v21, v38, v15
    v_sub_f32 v38, v16, v20
    v_mul_f32 v38, s60, v38
    v_exp_f32 v38, v38
    s_nop 0
    v_fmac_f32 v21, v38, v17
    v_sub_f32 v38, v18, v20
    v_mul_f32 v38, s60, v38
    v_exp_f32 v38, v38
    s_nop 0
    v_fmac_f32 v21, v38, v19
    s_lshl_b32 s58, s2, 7
    s_add_u32 s58, s58, 0xc0000
    s_mov_b64 exec, 255
    buffer_store_dwordx4 v[20:23], v4, s[44:47], s58 offen sc1
    s_mov_b64 exec, -1
    v_mov_b32 v38, 320
    s_mov_b32 s67, 0
L_lw4:
    ds_read_b32 v39, v38
    s_waitcnt lgkmcnt(0)
    v_readfirstlane_b32 s58, v39
    s_add_u32 s67, s67, 1
    s_and_b32 s58, s58, 0xf0
    s_cmp_eq_u32 s58, 0x40
    s_cbranch_scc1 L_lw4_ok
    s_sleep 16
    s_cmp_lt_u32 s67, 200000
    s_cbranch_scc1 L_lw4
L_lw4_ok:
    s_lshl_b32 s57, s29, 13
    s_add_u32 s57, s57, 0xc0000
    s_mov_b32 s67, 0
    v_lshlrev_b32 v3, 7, v1
    s_cmp_ge_u32 s32, 48
    s_cbranch_scc1 L_ml
    s_xor_b32 s58, s32, 8
    s_lshl_b32 s58, s58, 7
    v_mov_b32 v3, s58
L_ml:
    buffer_load_dwordx4 v[24:27], v3, s[44:47], s57 offen sc1
    s_add_u32 s67, s67, 1
    s_waitcnt vmcnt(0)
    v_xor_b32 v38, v26, v22
    v_xor_b32 v39, v27, v23
    v_or_b32 v38, v38, v39
    v_cmp_ne_u32 vcc, 0, v38
    s_nop 1
    s_cmp_eq_u64 vcc, 0
    s_cbranch_scc1 L_ml_ok
    s_sleep 16
    s_cmp_lt_u32 s67, 200000
    s_cbranch_scc1 L_ml
L_ml_ok:
    s_xor_b32 s58, s32, 8
    s_nop 0
    v_readlane_b32 s62, v24, s58
    v_readlane_b32 s63, v25, s58
    s_nop 1
    v_max_f32 v26, s62, v20
    v_sub_f32 v38, v20, v26
    v_sub_f32 v39, s62, v26
    v_mul_f32 v38, s60, v38
    v_mul_f32 v39, s60, v39
    v_exp_f32 v38, v38
    v_exp_f32 v39, v39
    s_nop 0
    v_mul_f32 v38, v38, v21
    v_fmac_f32 v38, s63, v39
    v_rcp_f32 v39, v38
    v_sub_f32 v40, v12, v26
    v_mul_f32 v40, s60, v40
    v_exp_f32 v40, v40
    s_nop 0
    v_mul_f32 v40, v40, v39
    v_sub_f32 v41, v14, v26
    v_mul_f32 v41, s60, v41
    v_exp_f32 v41, v41
    s_nop 0
    v_mul_f32 v41, v41, v39
    v_sub_f32 v42, v16, v26
    v_mul_f32 v42, s60, v42
    v_exp_f32 v42, v42
    s_nop 0
    v_mul_f32 v42, v42, v39
    v_sub_f32 v43, v18, v26
    v_mul_f32 v43, s60, v43
    v_exp_f32 v43, v43
    s_nop 0
    v_mul_f32 v43, v43, v39
    v_mov_b32 v38, 304
    s_mov_b64 exec, 1
    ds_write_b128 v38, v[40:43]
    s_mov_b64 exec, -1
    s_cmp_ge_u32 s32, 48
    s_cbranch_scc0 L_w3x
    s_cmp_eq_u32 s32, 48
    s_cbranch_scc0 L_neb
    s_lshl_b32 s58, s29, 7
    s_add_u32 s58, s58, 0xc9000
    v_lshlrev_b32 v39, 3, v1
    s_mov_b64 exec, 0xffff
    buffer_store_dwordx2 v[22:23], v39, s[44:47], s58 offen
    s_mov_b64 exec, -1
L_neb:
    s_mov_b32 s36, s4
    s_mov_b32 s37, s5
    s_mov_b32 s38, 0x1000
    s_mov_b32 s39, 0x00020000
    s_sub_u32 s60, s32, 48
    s_lshl_b32 s61, s60, 6
    s_lshl_b32 s58, s29, 10
    s_add_u32 s61, s61, s58
    buffer_load_ushort v204, v59, s[36:39], s61 offen
    v_cmp_gt_u32 vcc, 32, v1
    v_mov_b32 v41, 0x40000000
    s_nop 0
    v_cndmask_b32 v3, v41, v195, vcc
    s_lshl_b32 s56, s29, 16
    s_lshl_b32 s58, s60, 7
    s_add_u32 s56, s56, s58
    s_add_u32 s56, s56, 0x80000
    buffer_load_dwordx4 v[12:15], v192, s[44:47], s56 offen sc1
    buffer_load_dwordx4 v[16:19], v193, s[44:47], s56 offen sc1
    buffer_load_dwordx4 v[20:23], v194, s[44:47], s56 offen sc1
    buffer_load_dwordx4 v[24:27], v3, s[44:47], s56 offen sc1
    s_waitcnt vmcnt(0)
    v_pk_add_f32 v[12:13], v[12:13], v[20:21]
    v_pk_add_f32 v[14:15], v[14:15], v[22:23]
    v_pk_add_f32 v[16:17], v[16:17], v[24:25]
    v_pk_add_f32 v[18:19], v[18:19], v[26:27]
    v_pk_add_f32 v[12:13], v[12:13], v[16:17]
    v_pk_add_f32 v[14:15], v[14:15], v[18:19]
    s_nop 1
    v_permlane32_swap_b32 v12, v13
    v_permlane32_swap_b32 v14, v15
    v_add_f32 v12, v12, v13
    v_add_f32 v14, v14, v15
    s_nop 1
    v_permlane16_swap_b32 v12, v14
    v_add_f32 v12, v12, v14
    s_nop 1
    v_add_f32_dpp v12, v12, v12 row_ror:8 row_mask:0xf bank_mask:0xf
    v_cvt_pk_bf16_f32 v39, v12, v12
    v_and_b32 v12, 0xffff0000, v39
    v_mul_f32 v39, 0xbfb8aa3b, v12
    v_exp_f32 v39, v39
    s_nop 0
    v_add_f32 v39, 1.0, v39
    v_rcp_f32 v39, v39
    s_nop 0
    v_mul_f32 v12, v12, v39
    v_cvt_pk_bf16_f32 v39, v12, v12
    v_and_b32 v12, 0xffff0000, v39
    v_mov_b32 v200, v12
    v_lshlrev_b32 v204, 16, v204
    s_lshl_b32 s56, s29, 17
    s_lshl_b32 s58, s60, 7
    s_add_u32 s56, s56, s58
L_w3x:
    s_waitcnt lgkmcnt(0)
L_bar2:
    s_waitcnt vmcnt(0)
    s_mov_b32 s62, 0x05040100
    s_mov_b32 s63, 0x07060302
    v_perm_b32 v224, v68, v64, s62
    v_perm_b32 v225, v76, v72, s62
    v_perm_b32 v226, v84, v80, s62
    v_perm_b32 v227, v92, v88, s62
    v_perm_b32 v228, v68, v64, s63
    v_perm_b32 v229, v76, v72, s63
    v_perm_b32 v230, v84, v80, s63
    v_perm_b32 v231, v92, v88, s63
    v_perm_b32 v232, v69, v65, s62
    v_perm_b32 v233, v77, v73, s62
    v_perm_b32 v234, v85, v81, s62
    v_perm_b32 v235, v93, v89, s62
    v_perm_b32 v236, v69, v65, s63
    v_perm_b32 v237, v77, v73, s63
    v_perm_b32 v238, v85, v81, s63
    v_perm_b32 v239, v93, v89, s63
    v_perm_b32 v240, v70, v66, s62
    v_perm_b32 v241, v78, v74, s62
    v_perm_b32 v242, v86, v82, s62
    v_perm_b32 v243, v94, v90, s62
    v_perm_b32 v244, v70, v66, s63
    v_perm_b32 v245, v78, v74, s63
    v_perm_b32 v246, v86, v82, s63
    v_perm_b32 v247, v94, v90, s63
    v_perm_b32 v248, v71, v67, s62
    v_perm_b32 v249, v79, v75, s62
    v_perm_b32 v250, v87, v83, s62
    v_perm_b32 v251, v95, v91, s62
    v_perm_b32 v252, v71, v67, s63
    v_perm_b32 v253, v79, v75, s63
    v_perm_b32 v254, v87, v83, s63
    v_perm_b32 v255, v95, v91, s63
    v_perm_b32 v64, v100, v96, s62
    v_perm_b32 v65, v108, v104, s62
    v_perm_b32 v66, v116, v112, s62
    v_perm_b32 v67, v124, v120, s62
    v_perm_b32 v68, v100, v96, s63
    v_perm_b32 v69, v108, v104, s63
    v_perm_b32 v70, v116, v112, s63
    v_perm_b32 v71, v124, v120, s63
    v_perm_b32 v72, v101, v97, s62
    v_perm_b32 v73, v109, v105, s62
    v_perm_b32 v74, v117, v113, s62
    v_perm_b32 v75, v125, v121, s62
    v_perm_b32 v76, v101, v97, s63
    v_perm_b32 v77, v109, v105, s63
    v_perm_b32 v78, v117, v113, s63
    v_perm_b32 v79, v125, v121, s63
    v_perm_b32 v80, v102, v98, s62
    v_perm_b32 v81, v110, v106, s62
    v_perm_b32 v82, v118, v114, s62
    v_perm_b32 v83, v126, v122, s62
    v_perm_b32 v84, v102, v98, s63
    v_perm_b32 v85, v110, v106, s63
    v_perm_b32 v86, v118, v114, s63
    v_perm_b32 v87, v126, v122, s63
    v_perm_b32 v88, v103, v99, s62
    v_perm_b32 v89, v111, v107, s62
    v_perm_b32 v90, v119, v115, s62
    v_perm_b32 v91, v127, v123, s62
    v_perm_b32 v92, v103, v99, s63
    v_perm_b32 v93, v111, v107, s63
    v_perm_b32 v94, v119, v115, s63
    v_perm_b32 v95, v127, v123, s63
    v_perm_b32 v96, v132, v128, s62
    v_perm_b32 v97, v140, v136, s62
    v_perm_b32 v98, v148, v144, s62
    v_perm_b32 v99, v156, v152, s62
    v_perm_b32 v100, v132, v128, s63
    v_perm_b32 v101, v140, v136, s63
    v_perm_b32 v102, v148, v144, s63
    v_perm_b32 v103, v156, v152, s63
    v_perm_b32 v104, v133, v129, s62
    v_perm_b32 v105, v141, v137, s62
    v_perm_b32 v106, v149, v145, s62
    v_perm_b32 v107, v157, v153, s62
    v_perm_b32 v108, v133, v129, s63
    v_perm_b32 v109, v141, v137, s63
    v_perm_b32 v110, v149, v145, s63
    v_perm_b32 v111, v157, v153, s63
    v_perm_b32 v112, v134, v130, s62
    v_perm_b32 v113, v142, v138, s62
    v_perm_b32 v114, v150, v146, s62
    v_perm_b32 v115, v158, v154, s62
    v_perm_b32 v116, v134, v130, s63
    v_perm_b32 v117, v142, v138, s63
    v_perm_b32 v118, v150, v146, s63
    v_perm_b32 v119, v158, v154, s63
    v_perm_b32 v120, v135, v131, s62
    v_perm_b32 v121, v143, v139, s62
    v_perm_b32 v122, v151, v147, s62
    v_perm_b32 v123, v159, v155, s62
    v_perm_b32 v124, v135, v131, s63
    v_perm_b32 v125, v143, v139, s63
    v_perm_b32 v126, v151, v147, s63
    v_perm_b32 v127, v159, v155, s63
    v_perm_b32 v128, v164, v160, s62
    v_perm_b32 v129, v172, v168, s62
    v_perm_b32 v130, v180, v176, s62
    v_perm_b32 v131, v188, v184, s62
    v_perm_b32 v132, v164, v160, s63
    v_perm_b32 v133, v172, v168, s63
    v_perm_b32 v134, v180, v176, s63
    v_perm_b32 v135, v188, v184, s63
    v_perm_b32 v136, v165, v161, s62
    v_perm_b32 v137, v173, v169, s62
    v_perm_b32 v138, v181, v177, s62
    v_perm_b32 v139, v189, v185, s62
    v_perm_b32 v140, v165, v161, s63
    v_perm_b32 v141, v173, v169, s63
    v_perm_b32 v142, v181, v177, s63
    v_perm_b32 v143, v189, v185, s63
    v_perm_b32 v144, v166, v162, s62
    v_perm_b32 v145, v174, v170, s62
    v_perm_b32 v146, v182, v178, s62
    v_perm_b32 v147, v190, v186, s62
    v_perm_b32 v148, v166, v162, s63
    v_perm_b32 v149, v174, v170, s63
    v_perm_b32 v150, v182, v178, s63
    v_perm_b32 v151, v190, v186, s63
    v_perm_b32 v152, v167, v163, s62
    v_perm_b32 v153, v175, v171, s62
    v_perm_b32 v154, v183, v179, s62
    v_perm_b32 v155, v191, v187, s62
    v_perm_b32 v156, v167, v163, s63
    v_perm_b32 v157, v175, v171, s63
    v_perm_b32 v158, v183, v179, s63
    v_perm_b32 v159, v191, v187, s63
    v_and_b32 v38, 3, v6
    v_mul_u32_u24 v38, 320, v38
    v_lshlrev_b32 v41, 4, v5
    v_add_u32 v38, 2048, v38
    v_add_u32 v38, v38, v41
    v_xor_b32 v39, 544, v41
    v_and_b32 v40, 4, v6
    v_cmp_eq_u32 vcc, 0, v40
    s_nop 1
    v_cndmask_b32 v56, v39, v38, vcc
    v_cndmask_b32 v57, v38, v39, vcc
    v_lshlrev_b32 v38, 4, v6
    v_lshl_add_u32 v38, v5, 2, v38
    v_mov_b32 v39, 304
    s_lshl_b32 s57, s2, 11
    s_lshl_b32 s58, s33, 9
    s_add_u32 s57, s57, s58
    s_mov_b32 s36, s22
    s_mov_b32 s37, s23
    s_mov_b32 s38, 0x1000
    s_mov_b32 s39, 0x00020000
    s_cmp_ge_u32 s32, 48
    s_cselect_b32 s68, 1, 0
    s_cmp_eq_u32 s33, 3
    s_cselect_b32 s68, s68, 0
    s_barrier
    ds_read_b128 v[12:15], v56 offset:0
    ds_read_b128 v[16:19], v57 offset:0
    ds_read_b128 v[20:23], v56 offset:64
    ds_read_b128 v[24:27], v57 offset:64
    ds_read_b128 v[208:211], v56 offset:128
    ds_read_b128 v[212:215], v57 offset:128
    ds_read_b128 v[216:219], v56 offset:192
    ds_read_b128 v[220:223], v57 offset:192
    ds_read_b128 v[40:43], v39
    s_waitcnt lgkmcnt(7)
    v_mfma_f32_16x16x32_bf16 v[28:31], v[12:15], v[224:227], 0
    v_mfma_f32_16x16x32_bf16 v[28:31], v[16:19], v[240:243], v[28:31]
    v_mfma_f32_16x16x32_bf16 v[32:35], v[12:15], v[228:231], 0
    v_mfma_f32_16x16x32_bf16 v[32:35], v[16:19], v[244:247], v[32:35]
    v_mfma_f32_16x16x32_bf16 v[48:51], v[12:15], v[232:235], 0
    v_mfma_f32_16x16x32_bf16 v[48:51], v[16:19], v[248:251], v[48:51]
    v_mfma_f32_16x16x32_bf16 v[52:55], v[12:15], v[236:239], 0
    v_mfma_f32_16x16x32_bf16 v[52:55], v[16:19], v[252:255], v[52:55]
    s_waitcnt lgkmcnt(5)
    v_mfma_f32_16x16x32_bf16 v[28:31], v[20:23], v[64:67], v[28:31]
    s_cmp_eq_u32 s68, 1
    s_cbranch_scc0 L_ne8
    buffer_load_dwordx4 v[160:163], v192, s[44:47], s56 offen sc1
    buffer_load_dwordx4 v[164:167], v193, s[44:47], s56 offen sc1
    buffer_load_dwordx4 v[168:171], v194, s[44:47], s56 offen sc1
    buffer_load_dwordx4 v[172:175], v195, s[44:47], s56 offen sc1
    buffer_load_dwordx4 v[176:179], v196, s[44:47], s56 offen sc1
    buffer_load_dwordx4 v[180:183], v197, s[44:47], s56 offen sc1
    buffer_load_dwordx4 v[184:187], v198, s[44:47], s56 offen sc1
    buffer_load_dwordx4 v[188:191], v199, s[44:47], s56 offen sc1
L_ne8:
    v_mfma_f32_16x16x32_bf16 v[28:31], v[24:27], v[80:83], v[28:31]
    v_mfma_f32_16x16x32_bf16 v[32:35], v[20:23], v[68:71], v[32:35]
    v_mfma_f32_16x16x32_bf16 v[32:35], v[24:27], v[84:87], v[32:35]
    v_mfma_f32_16x16x32_bf16 v[48:51], v[20:23], v[72:75], v[48:51]
    v_mfma_f32_16x16x32_bf16 v[48:51], v[24:27], v[88:91], v[48:51]
    v_mfma_f32_16x16x32_bf16 v[52:55], v[20:23], v[76:79], v[52:55]
    v_mfma_f32_16x16x32_bf16 v[52:55], v[24:27], v[92:95], v[52:55]
    s_waitcnt lgkmcnt(3)
    v_mfma_f32_16x16x32_bf16 v[28:31], v[208:211], v[96:99], v[28:31]
    v_mfma_f32_16x16x32_bf16 v[28:31], v[212:215], v[112:115], v[28:31]
    v_mfma_f32_16x16x32_bf16 v[32:35], v[208:211], v[100:103], v[32:35]
    v_mfma_f32_16x16x32_bf16 v[32:35], v[212:215], v[116:119], v[32:35]
    v_mfma_f32_16x16x32_bf16 v[48:51], v[208:211], v[104:107], v[48:51]
    v_mfma_f32_16x16x32_bf16 v[48:51], v[212:215], v[120:123], v[48:51]
    v_mfma_f32_16x16x32_bf16 v[52:55], v[208:211], v[108:111], v[52:55]
    v_mfma_f32_16x16x32_bf16 v[52:55], v[212:215], v[124:127], v[52:55]
    s_waitcnt lgkmcnt(1)
    v_mfma_f32_16x16x32_bf16 v[28:31], v[216:219], v[128:131], v[28:31]
    v_mfma_f32_16x16x32_bf16 v[28:31], v[220:223], v[144:147], v[28:31]
    v_mfma_f32_16x16x32_bf16 v[32:35], v[216:219], v[132:135], v[32:35]
    v_mfma_f32_16x16x32_bf16 v[32:35], v[220:223], v[148:151], v[32:35]
    v_mfma_f32_16x16x32_bf16 v[48:51], v[216:219], v[136:139], v[48:51]
    v_mfma_f32_16x16x32_bf16 v[48:51], v[220:223], v[152:155], v[48:51]
    v_mfma_f32_16x16x32_bf16 v[52:55], v[216:219], v[140:143], v[52:55]
    v_mfma_f32_16x16x32_bf16 v[52:55], v[220:223], v[156:159], v[52:55]
    s_waitcnt lgkmcnt(0)
    s_mov_b32 exec_hi, 0
    v_pk_mul_f32 v[44:45], v[28:29], v[40:41]
    v_pk_fma_f32 v[44:45], v[30:31], v[42:43], v[44:45]
    v_add_f32 v12, v44, v45
    v_min_u32 v12, -2, v12
    v_pk_mul_f32 v[44:45], v[32:33], v[40:41]
    v_pk_fma_f32 v[44:45], v[34:35], v[42:43], v[44:45]
    v_add_f32 v13, v44, v45
    v_min_u32 v13, -2, v13
    v_pk_mul_f32 v[44:45], v[48:49], v[40:41]
    v_pk_fma_f32 v[44:45], v[50:51], v[42:43], v[44:45]
    v_add_f32 v14, v44, v45
    v_min_u32 v14, -2, v14
    v_pk_mul_f32 v[44:45], v[52:53], v[40:41]
    v_pk_fma_f32 v[44:45], v[54:55], v[42:43], v[44:45]
    v_add_f32 v15, v44, v45
    v_min_u32 v15, -2, v15
    buffer_store_dwordx4 v[12:15], v58, s[44:47], s57 offen sc1
    s_mov_b64 exec, -1
    s_cmp_eq_u32 s68, 1
    s_cbranch_scc0 L_auxend
    s_mov_b32 s67, 0
L_p2:
    buffer_load_dwordx4 v[64:67], v192, s[44:47], s56 offen sc1
    buffer_load_dwordx4 v[68:71], v193, s[44:47], s56 offen sc1
    buffer_load_dwordx4 v[72:75], v194, s[44:47], s56 offen sc1
    buffer_load_dwordx4 v[76:79], v195, s[44:47], s56 offen sc1
    buffer_load_dwordx4 v[80:83], v196, s[44:47], s56 offen sc1
    buffer_load_dwordx4 v[84:87], v197, s[44:47], s56 offen sc1
    buffer_load_dwordx4 v[88:91], v198, s[44:47], s56 offen sc1
    buffer_load_dwordx4 v[92:95], v199, s[44:47], s56 offen sc1
    s_waitcnt vmcnt(15)
    v_max3_u32 v38, v160, v161, v162
    v_max_u32 v38, v38, v163
    s_waitcnt vmcnt(14)
    v_max3_u32 v38, v38, v164, v165
    v_max3_u32 v38, v38, v166, v167
    v_pk_add_f32 v[128:129], v[160:161], v[164:165]
    v_pk_add_f32 v[130:131], v[162:163], v[166:167]
    s_waitcnt vmcnt(13)
    v_max3_u32 v38, v38, v168, v169
    v_max3_u32 v38, v38, v170, v171
    v_pk_add_f32 v[128:129], v[128:129], v[168:169]
    v_pk_add_f32 v[130:131], v[130:131], v[170:171]
    s_waitcnt vmcnt(12)
    v_max3_u32 v38, v38, v172, v173
    v_max3_u32 v38, v38, v174, v175
    v_pk_add_f32 v[128:129], v[128:129], v[172:173]
    v_pk_add_f32 v[130:131], v[130:131], v[174:175]
    s_waitcnt vmcnt(11)
    v_max3_u32 v38, v38, v176, v177
    v_max3_u32 v38, v38, v178, v179
    v_pk_add_f32 v[128:129], v[128:129], v[176:177]
    v_pk_add_f32 v[130:131], v[130:131], v[178:179]
    s_waitcnt vmcnt(10)
    v_max3_u32 v38, v38, v180, v181
    v_max3_u32 v38, v38, v182, v183
    v_pk_add_f32 v[128:129], v[128:129], v[180:181]
    v_pk_add_f32 v[130:131], v[130:131], v[182:183]
    s_waitcnt vmcnt(9)
    v_max3_u32 v38, v38, v184, v185
    v_max3_u32 v38, v38, v186, v187
    v_pk_add_f32 v[128:129], v[128:129], v[184:185]
    v_pk_add_f32 v[130:131], v[130:131], v[186:187]
    s_waitcnt vmcnt(8)
    v_max3_u32 v38, v38, v188, v189
    v_max3_u32 v38, v38, v190, v191
    v_pk_add_f32 v[128:129], v[128:129], v[188:189]
    v_pk_add_f32 v[130:131], v[130:131], v[190:191]
    v_cmp_eq_u32 vcc, -1, v38
    s_nop 1
    s_cmp_eq_u64 vcc, 0
    s_cbranch_scc1 L_p2c
    buffer_load_dwordx4 v[160:163], v192, s[44:47], s56 offen sc1
    buffer_load_dwordx4 v[164:167], v193, s[44:47], s56 offen sc1
    buffer_load_dwordx4 v[168:171], v194, s[44:47], s56 offen sc1
    buffer_load_dwordx4 v[172:175], v195, s[44:47], s56 offen sc1
    buffer_load_dwordx4 v[176:179], v196, s[44:47], s56 offen sc1
    buffer_load_dwordx4 v[180:183], v197, s[44:47], s56 offen sc1
    buffer_load_dwordx4 v[184:187], v198, s[44:47], s56 offen sc1
    buffer_load_dwordx4 v[188:191], v199, s[44:47], s56 offen sc1
    s_waitcnt vmcnt(15)
    v_max3_u32 v38, v64, v65, v66
    v_max_u32 v38, v38, v67
    s_waitcnt vmcnt(14)
    v_max3_u32 v38, v38, v68, v69
    v_max3_u32 v38, v38, v70, v71
    v_pk_add_f32 v[128:129], v[64:65], v[68:69]
    v_pk_add_f32 v[130:131], v[66:67], v[70:71]
    s_waitcnt vmcnt(13)
    v_max3_u32 v38, v38, v72, v73
    v_max3_u32 v38, v38, v74, v75
    v_pk_add_f32 v[128:129], v[128:129], v[72:73]
    v_pk_add_f32 v[130:131], v[130:131], v[74:75]
    s_waitcnt vmcnt(12)
    v_max3_u32 v38, v38, v76, v77
    v_max3_u32 v38, v38, v78, v79
    v_pk_add_f32 v[128:129], v[128:129], v[76:77]
    v_pk_add_f32 v[130:131], v[130:131], v[78:79]
    s_waitcnt vmcnt(11)
    v_max3_u32 v38, v38, v80, v81
    v_max3_u32 v38, v38, v82, v83
    v_pk_add_f32 v[128:129], v[128:129], v[80:81]
    v_pk_add_f32 v[130:131], v[130:131], v[82:83]
    s_waitcnt vmcnt(10)
    v_max3_u32 v38, v38, v84, v85
    v_max3_u32 v38, v38, v86, v87
    v_pk_add_f32 v[128:129], v[128:129], v[84:85]
    v_pk_add_f32 v[130:131], v[130:131], v[86:87]
    s_waitcnt vmcnt(9)
    v_max3_u32 v38, v38, v88, v89
    v_max3_u32 v38, v38, v90, v91
    v_pk_add_f32 v[128:129], v[128:129], v[88:89]
    v_pk_add_f32 v[130:131], v[130:131], v[90:91]
    s_waitcnt vmcnt(8)
    v_max3_u32 v38, v38, v92, v93
    v_max3_u32 v38, v38, v94, v95
    v_pk_add_f32 v[128:129], v[128:129], v[92:93]
    v_pk_add_f32 v[130:131], v[130:131], v[94:95]
    v_cmp_eq_u32 vcc, -1, v38
    s_nop 1
    s_cmp_eq_u64 vcc, 0
    s_cbranch_scc1 L_p2c
    s_add_u32 s67, s67, 1
    s_cmp_lt_u32 s67, 200000
    s_cbranch_scc1 L_p2
L_p2c:
    v_permlane32_swap_b32 v128, v129
    v_permlane32_swap_b32 v130, v131
    v_add_f32 v128, v128, v129
    v_add_f32 v130, v130, v131
    s_nop 1
    v_permlane16_swap_b32 v128, v130
    v_add_f32 v128, v128, v130
    s_nop 1
    v_add_f32_dpp v128, v128, v128 row_ror:8 row_mask:0xf bank_mask:0xf
    s_mov_b32 exec_lo, 0x00ff00ff
    s_mov_b32 exec_hi, 0x00ff00ff
    v_cvt_pk_bf16_f32 v38, v128, v128
    v_and_b32 v128, 0xffff0000, v38
    v_mul_f32 v128, v128, v200
    v_cvt_pk_bf16_f32 v38, v128, v128
    v_and_b32 v128, 0xffff0000, v38
    v_add_f32 v128, v128, v204
    v_cvt_pk_bf16_f32 v128, v128, v128
    buffer_store_short v128, v59, s[36:39], s61 offen
    s_mov_b64 exec, -1
L_auxend:
L_end:
    s_endpgm
.section .rodata,"a"
.p2align 6
.amdhsa_kernel recurrent_scan__mha_block_cached__glu_gated_swiglu__decode_kernel
  .amdhsa_next_free_vgpr 256
  .amdhsa_next_free_sgpr 80
  .amdhsa_accum_offset 256
  .amdhsa_group_segment_fixed_size 0
  .amdhsa_kernarg_size 96
  .amdhsa_user_sgpr_count 2
  .amdhsa_user_sgpr_kernarg_segment_ptr 1
  .amdhsa_system_sgpr_workgroup_id_x 1
.end_amdhsa_kernel
```
